```python
import torch

def _softmax(x, axis=-1):
    return torch.softmax(x, dim=axis)

def _gelu(x):
    return torch.nn.functional.gelu(x, approximate='tanh')

def _silu(x):
    return torch.nn.functional.silu(x)

def _sigmoid(x):
    return torch.sigmoid(x)

def _layernorm(x, axis=-1, eps=1e-05):
    m = x.mean(dim=axis, keepdim=True)
    v = x.var(dim=axis, keepdim=True, unbiased=False)
    return (x - m) / torch.sqrt(v + eps)

def _scatter_add(tgt, idx, src, axis=0):
    return tgt.clone().index_add_(axis, idx, src)

def _segment_sum(src, seg, n):
    out = torch.zeros((n,) + src.shape[1:], dtype=src.dtype)
    return out.index_add_(0, seg, src)

def _pad(x, pw):
    flat = tuple((v for pair in reversed(pw) for v in pair))
    return torch.nn.functional.pad(x, flat)
kernel_name = 'standalone__autoregressive_conv_wavenet__speech'

def setup_inputs():

    _w = lambda a: (lambda t: t.to(torch.bfloat16) if t.is_floating_point() else t)(torch.as_tensor(a))
    B, T, D, K = (2, 16000, 144, 5)
    return {'x': _w((lambda *s: torch.randn(*s, dtype=torch.bfloat16) * 0.1)(B, T, D)), 'w': _w((lambda *s: torch.randn(*s, dtype=torch.bfloat16) * 0.1)(K, D, 2 * D)), 'w_o': _w((lambda *s: torch.randn(*s, dtype=torch.bfloat16) * 0.05)(D, D))}

def reference(x, w, w_o):
    B, T, D = x.shape
    K = w.shape[0]
    dil = 2
    pad = (K - 1) * dil
    xp = _pad(x, ((0, 0), (pad, 0), (0, 0)))
    h = torch.einsum('btc,cd->btd', xp[:, pad:pad + T, :], w[0])
    for i in range(1, K):
        off = pad - i * dil
        h = h + torch.einsum('btc,cd->btd', xp[:, off:off + T, :], w[i])
    f = h[..., :D].clone()
    g = h[..., D:].clone()
    z = torch.tanh(f) * _sigmoid(g)
    return z @ w_o
```

```asm
; @launch grid=(250,1,1) block=(512,1,1) lds=154368
.amdgcn_target "amdgcn-amd-amdhsa--gfx950"
.text
.globl standalone__autoregressive_conv_wavenet__speech_kernel
.p2align 8
.type standalone__autoregressive_conv_wavenet__speech_kernel,@function
standalone__autoregressive_conv_wavenet__speech_kernel:
    s_load_dwordx8 s[4:11], s[0:1], 0
    s_cmp_ge_u32 s2, 250
    s_cbranch_scc1 L_end
    v_lshrrev_b32 v12, 6, v0
    v_and_b32 v240, 63, v0
    s_getpc_b64 s[50:51]
L_pc:
    s_bfe_u32 s52, s2, 0x20003
    s_lshl_b32 s52, s52, 6
    v_lshl_add_u32 v1, v12, 3, v240
    v_add_lshl_u32 v1, v1, s52, 7
    v_min_u32 v1, L_code_end-L_pc-4, v1
    s_mov_b64 exec, 0xff
    global_load_dword v2, v1, s[50:51]
    s_mov_b64 exec, -1
    v_readfirstlane_b32 s36, v12
    v_and_b32 v13, 2, v12
    v_xor_b32 v13, v13, v240
    v_lshlrev_b32 v13, 4, v13
    s_mul_i32 s41, s2, 36864
    s_sub_u32 s41, s41, 2304
    s_cmp_eq_u32 s2, 0
    s_cselect_b32 s42, 144, 0
    s_cmp_eq_u32 s2, 125
    s_cselect_b32 s42, 144, s42
    v_lshl_add_u32 v14, v0, 4, s41
    v_cmp_gt_u32 vcc, s42, v0
    v_mov_b32 v16, 0x7fff0000
    v_add_u32 v17, 8192, v14
    v_cndmask_b32 v15, v14, v16, vcc
    s_lshr_b32 s45, s2, 3
    s_lshl_b32 s45, s45, 3
    s_add_u32 s45, s45, s36
    s_mul_i32 s45, s45, 4
    s_addk_i32 s45, 144
    v_add_lshl_u32 v18, v240, s45, 7
    s_mul_i32 s43, s36, 2304
    s_lshl_b32 s56, s36, 10
    s_mov_b32 s18, 9216000
    s_mov_b32 s19, 0x20000
    s_mov_b32 s22, 414720
    s_mov_b32 s23, 0x20000
    s_add_u32 m0, s43, 131328
    s_and_b32 s39, s36, 3
    s_waitcnt lgkmcnt(0)
    s_mov_b32 s20, s6
    s_mov_b32 s21, s7
    s_mov_b32 s16, s4
    s_mov_b32 s17, s5
    s_mov_b64 exec, 15
    buffer_load_dword v3, v18, s[20:23], 0 offen
    s_mov_b64 exec, -1
    buffer_load_dwordx4 v13, s[20:23], s43 offen  lds
    buffer_load_dwordx4 v13, s[20:23], s43 offen offset:1024  lds
    s_mov_b64 exec, 0xffff
    buffer_load_dwordx4 v13, s[20:23], s43 offen offset:2048  lds
    s_mov_b64 exec, -1
    s_mov_b32 m0, s56
    s_movk_i32 s45, 8192
    buffer_load_dwordx4 v15, s[16:19], 0 offen nt lds
    s_add_u32 m0, s56, 8192
    s_mul_i32 s53, s39, 4608
    buffer_load_dwordx4 v17, s[16:19], 0 offen nt lds
    s_add_u32 m0, s56, 16384
    s_add_u32 s52, s53, 3072
    buffer_load_dwordx4 v17, s[16:19], s45 offen nt lds
    s_mov_b32 s28, s10
    s_mov_b32 s29, s11
    s_mov_b32 s30, 9216000
    s_mov_b32 s31, 0x20000
    s_mov_b32 s26, 41472
    s_mov_b32 s27, 0x20000
    s_mov_b32 s24, s8
    s_mov_b32 s25, s9
    s_and_b32 s40, s39, 1
    s_lshl_b32 s40, s40, 1
    v_xor_b32 v236, s40, v240
    v_lshlrev_b32 v236, 4, v236
    v_lshlrev_b32 v237, 4, v240
    v_lshrrev_b32 v4, 4, v240
    v_and_b32 v5, 15, v240
    v_bfe_u32 v6, v240, 2, 2
    v_and_b32 v7, 3, v240
    s_movk_i32 s44, 288
    s_movk_i32 s45, 576
    v_mul_u32_u24 v11, s44, v5
    v_lshl_add_u32 v11, v4, 4, v11
    v_lshrrev_b32 v10, 1, v4
    v_mul_u32_u24 v8, 864, v10
    v_sub_u32 v8, 832, v8
    s_and_b32 s46, s36, 4
    s_mul_i32 s57, s46, 9792
    s_add_u32 s40, s39, 0
    s_and_b32 s40, s40, 3
    s_mul_i32 s12, s40, 9216
    s_add_u32 s40, s40, s46
    s_mul_i32 s40, s40, 4608
    v_add_u32 v224, s40, v11
    v_add_u32 v228, v224, v8
    s_add_u32 s40, s39, 1
    s_and_b32 s40, s40, 3
    s_mul_i32 s13, s40, 9216
    s_lshl_b32 s41, s40, 12
    s_add_u32 s41, s41, s57
    v_add_u32 v250, s41, v237
    s_add_u32 s40, s40, s46
    s_mul_i32 s40, s40, 4608
    v_add_u32 v225, s40, v11
    v_add_u32 v229, v225, v8
    s_add_u32 s40, s39, 2
    s_and_b32 s40, s40, 3
    s_mul_i32 s14, s40, 9216
    s_lshl_b32 s41, s40, 12
    s_add_u32 s41, s41, s57
    v_add_u32 v251, s41, v237
    s_add_u32 s40, s40, s46
    s_mul_i32 s40, s40, 4608
    v_add_u32 v226, s40, v11
    v_add_u32 v230, v226, v8
    s_add_u32 s40, s39, 3
    s_and_b32 s40, s40, 3
    s_mul_i32 s15, s40, 9216
    s_lshl_b32 s41, s40, 12
    s_add_u32 s41, s41, s57
    v_add_u32 v252, s41, v237
    s_add_u32 s40, s40, s46
    s_mul_i32 s40, s40, 4608
    v_add_u32 v227, s40, v11
    v_add_u32 v231, v227, v8
    s_lshl_b32 s40, s39, 12
    s_add_u32 s40, s40, s57
    v_add_u32 v253, s40, v237
    v_lshl_add_u32 v8, v4, 3, v6
    v_mul_u32_u24 v8, s45, v8
    v_lshl_add_u32 v8, v7, 3, v8
    v_and_b32 v9, 1, v4
    v_lshlrev_b32 v9, 5, v9
    v_add_u32 v8, 39168, v8
    v_add_u32 v220, v8, v9
    v_sub_u32 v221, v8, v9
    v_add_u32 v222, 55296, v220
    v_add_u32 v223, 55296, v221
    s_lshl_b32 s40, s39, 6
    v_add_u32 v232, s40, v220
    v_add_u32 v233, s40, v221
    v_add_u32 v234, s40, v222
    v_add_u32 v235, s40, v223
    v_lshl_add_u32 v8, v4, 2, v6
    v_mul_u32_u24 v8, s44, v8
    v_add_u32 v8, 112896, v8
    v_lshl_add_u32 v241, v7, 3, v8
    s_mul_i32 s41, s36, 4608
    s_mul_i32 s48, s2, 36864
    s_add_u32 s48, s48, s41
    s_add_u32 s41, s41, 55552
    v_bfe_u32 v9, v5, 2, 1
    v_xor_b32 v10, v10, v9
    v_lshl_add_u32 v10, v10, 4, s41
    v_and_b32 v11, 1, v4
    v_lshl_add_u32 v10, v11, 3, v10
    v_mad_u32_u24 v242, v5, s44, v10
    v_add_u32 v243, s41, v237
    v_add_u32 v8, 0, v240
    v_mul_u32_u24 v9, 58255, v8
    v_bfe_u32 v9, v9, 22, 1
    v_xor_b32 v9, v9, v8
    v_lshl_add_u32 v244, v9, 4, s48
    v_add_u32 v8, 64, v240
    v_mul_u32_u24 v9, 58255, v8
    v_bfe_u32 v9, v9, 22, 1
    v_xor_b32 v9, v9, v8
    v_lshl_add_u32 v245, v9, 4, s48
    v_add_u32 v8, 128, v240
    v_mul_u32_u24 v9, 58255, v8
    v_bfe_u32 v9, v9, 22, 1
    v_xor_b32 v9, v9, v8
    v_lshl_add_u32 v246, v9, 4, s48
    v_add_u32 v8, 192, v240
    v_mul_u32_u24 v9, 58255, v8
    v_bfe_u32 v9, v9, 22, 1
    v_xor_b32 v9, v9, v8
    v_lshl_add_u32 v247, v9, 4, s48
    v_add_u32 v8, 256, v240
    v_mul_u32_u24 v9, 58255, v8
    v_bfe_u32 v9, v9, 22, 1
    v_xor_b32 v9, v9, v8
    v_lshl_add_u32 v248, v9, 4, s48
    s_add_u32 s40, s53, 405504
    v_add_u32 v238, s40, v236
    v_add_u32 v239, 3072, v238
    s_lshl_b32 s58, s39, 9
    s_add_u32 s58, s58, 16384
    s_mov_b32 s40, 0x4038aa3b
    s_mov_b32 s41, 0x4038aa3b
    s_mov_b32 s42, 0xbfb8aa3b
    s_mov_b32 s43, 0xbfb8aa3b
    s_mov_b32 s44, 0x41800000
    s_add_u32 m0, s56, 24576
    s_movk_i32 s45, 16384
    buffer_load_dwordx4 v17, s[16:19], s45 offen nt lds
    s_mul_i32 s45, s36, 800
    s_add_u32 m0, s45, 32768
    s_mul_i32 s45, s36, 224
    s_sub_u32 s45, 24576, s45
    s_mov_b32 exec_hi, 0x3ffff
    buffer_load_dwordx4 v17, s[16:19], s45 offen nt lds
    s_mov_b32 exec_hi, -1
    s_waitcnt vmcnt(5)
    s_barrier
    s_cmp_ge_u32 s36, 4
    s_cbranch_scc1 L_V
    s_lshr_b32 s45, s2, 3
    s_min_u32 s45, s45, 30
    s_mul_i32 s45, s45, 104
    s_mul_i32 s46, s39, 26
    s_add_u32 s45, s45, s46
    v_add_lshl_u32 v163, v240, s45, 7
    v_add_u32 v162, 55296, v163
    v_subrev_u32 v163, 359424, v163
    ds_read_b64_tr_b16 v[100:101], v234 offset:36864
    ds_read_b64_tr_b16 v[102:103], v234 offset:39168
    ds_read_b64_tr_b16 v[104:105], v235 offset:36896
    ds_read_b64_tr_b16 v[106:107], v235 offset:39200
    ds_read_b64_tr_b16 v[108:109], v235 offset:37152
    ds_read_b64_tr_b16 v[110:111], v235 offset:39456
    ds_read_b64_tr_b16 v[112:113], v234 offset:37184
    ds_read_b64_tr_b16 v[114:115], v234 offset:39488
    ds_read_b64_tr_b16 v[116:117], v222 offset:37120
    ds_read_b64_tr_b16 v[118:119], v222 offset:39424
    ds_read_b64_tr_b16 v[120:121], v223 offset:37408
    ds_read_b64_tr_b16 v[122:123], v223 offset:39712
    s_mov_b32 s47, s39
    s_mov_b64 exec, 0
L_wloop:
    s_cmp_eq_u32 s47, 0
    s_cbranch_scc1 L_wp0
    s_cmp_eq_u32 s47, 1
    s_cbranch_scc1 L_wp1
    s_cmp_eq_u32 s47, 2
    s_cbranch_scc1 L_wp2
    s_cmp_eq_u32 s47, 3
    s_cbranch_scc1 L_wp3
    s_cmp_eq_u32 s47, 4
    s_cbranch_scc1 L_wp4
    s_branch L_wdone
L_wback:
    s_add_u32 s47, s47, 4
    s_branch L_wloop
L_wdone:
    s_mov_b64 exec, -1
L_m_U0:
    s_waitcnt vmcnt(0)
    s_barrier
    ds_read_b128 v[80:83], v224 offset:2304
    ds_read_b128 v[96:99], v224 offset:20736
    ds_read_b128 v[84:87], v225 offset:2304
    ds_read_b128 v[88:91], v226 offset:2304
    ds_read_b128 v[92:95], v227 offset:2304
    s_add_u32 m0, s53, 76032
    s_add_u32 s54, s53, 55296
    buffer_load_dwordx4 v236, s[20:23], s54 offen offset:0  lds
    buffer_load_dwordx4 v236, s[20:23], s54 offen offset:1024  lds
    buffer_load_dwordx4 v236, s[20:23], s54 offen offset:2048  lds
    s_add_u32 m0, s52, 76032
    s_add_u32 s54, s52, 55296
    buffer_load_dwordx4 v236, s[20:23], s54 offen offset:0  lds
    s_mov_b32 exec_hi, 0
    buffer_load_dwordx4 v236, s[20:23], s54 offen offset:1024  lds
    s_mov_b32 exec_hi, -1
    s_add_u32 m0, s52, 94464
    s_add_u32 s54, s52, 73728
    buffer_load_dwordx4 v236, s[20:23], s54 offen offset:0  lds
    s_mov_b32 exec_hi, 0
    buffer_load_dwordx4 v236, s[20:23], s54 offen offset:1024  lds
    s_mov_b32 exec_hi, -1
    s_waitcnt lgkmcnt(4)
    v_mfma_f32_16x16x32_bf16 v[0:3], v[100:103], v[80:83], 0
L_m_U1:
    s_barrier
    v_mfma_f32_16x16x32_bf16 v[4:7], v[104:107], v[80:83], 0
    ds_read_b64_tr_b16 v[124:125], v232 offset:0
    v_mfma_f32_16x16x32_bf16 v[8:11], v[108:111], v[80:83], 0
    ds_read_b64_tr_b16 v[126:127], v232 offset:2304
    v_mfma_f32_16x16x32_bf16 v[12:15], v[112:115], v[80:83], 0
    ds_read_b64_tr_b16 v[128:129], v233 offset:32
    v_mfma_f32_16x16x32_bf16 v[64:67], v[116:119], v[80:83], 0
    ds_read_b64_tr_b16 v[130:131], v233 offset:2336
    v_mfma_f32_16x16x32_bf16 v[72:75], v[120:123], v[80:83], 0
    ds_read_b128 v[80:83], v224 offset:2368
    s_waitcnt lgkmcnt(8)
    v_mfma_f32_16x16x32_bf16 v[68:71], v[116:119], v[96:99], 0
    ds_read_b64_tr_b16 v[132:133], v233 offset:288
    v_mfma_f32_16x16x32_bf16 v[76:79], v[120:123], v[96:99], 0
    ds_read_b128 v[96:99], v224 offset:20800
    s_waitcnt lgkmcnt(9)
    v_mfma_f32_16x16x32_bf16 v[16:19], v[100:103], v[84:87], 0
    ds_read_b64_tr_b16 v[134:135], v233 offset:2592
    v_mfma_f32_16x16x32_bf16 v[20:23], v[104:107], v[84:87], 0
    ds_read_b64_tr_b16 v[136:137], v232 offset:320
    v_mfma_f32_16x16x32_bf16 v[24:27], v[108:111], v[84:87], 0
    ds_read_b64_tr_b16 v[138:139], v232 offset:2624
    v_mfma_f32_16x16x32_bf16 v[28:31], v[112:115], v[84:87], 0
    ds_read_b128 v[84:87], v225 offset:2368
    s_waitcnt lgkmcnt(9)
    v_mfma_f32_16x16x32_bf16 v[32:35], v[100:103], v[88:91], 0
    ds_read_b64_tr_b16 v[140:141], v220 offset:256
    v_mfma_f32_16x16x32_bf16 v[36:39], v[104:107], v[88:91], 0
    ds_read_b64_tr_b16 v[142:143], v220 offset:2560
    v_mfma_f32_16x16x32_bf16 v[40:43], v[108:111], v[88:91], 0
    ds_read_b64_tr_b16 v[144:145], v221 offset:544
    v_mfma_f32_16x16x32_bf16 v[44:47], v[112:115], v[88:91], 0
    ds_read_b128 v[88:91], v226 offset:2368
    v_mfma_f32_16x16x32_bf16 v[48:51], v[100:103], v[92:95], 0
    ds_read_b64_tr_b16 v[146:147], v221 offset:2848
    v_mfma_f32_16x16x32_bf16 v[52:55], v[104:107], v[92:95], 0
    v_mfma_f32_16x16x32_bf16 v[56:59], v[108:111], v[92:95], 0
    v_mfma_f32_16x16x32_bf16 v[60:63], v[112:115], v[92:95], 0
    ds_read_b128 v[92:95], v227 offset:2368
    s_waitcnt lgkmcnt(9)
    v_mfma_f32_16x16x32_bf16 v[0:3], v[124:127], v[80:83], v[0:3]
    s_add_u32 m0, s52, 112896
    s_add_u32 s54, s52, 92160
    buffer_load_dwordx4 v236, s[20:23], s54 offen offset:0  lds
    s_mov_b32 exec_hi, 0
    buffer_load_dwordx4 v236, s[20:23], s54 offen offset:1024  lds
    s_mov_b32 exec_hi, -1
L_m_U2:
    s_barrier
    v_mfma_f32_16x16x32_bf16 v[4:7], v[128:131], v[80:83], v[4:7]
    ds_read_b64_tr_b16 v[100:101], v232 offset:18432
    v_mfma_f32_16x16x32_bf16 v[8:11], v[132:135], v[80:83], v[8:11]
    ds_read_b64_tr_b16 v[102:103], v232 offset:20736
    s_waitcnt lgkmcnt(9)
    v_mfma_f32_16x16x32_bf16 v[12:15], v[136:139], v[80:83], v[12:15]
    ds_read_b64_tr_b16 v[104:105], v233 offset:18464
    s_waitcnt lgkmcnt(7)
    v_mfma_f32_16x16x32_bf16 v[64:67], v[140:143], v[80:83], v[64:67]
    ds_read_b64_tr_b16 v[106:107], v233 offset:20768
    s_waitcnt lgkmcnt(5)
    v_mfma_f32_16x16x32_bf16 v[72:75], v[144:147], v[80:83], v[72:75]
    ds_read_b128 v[80:83], v224 offset:2432
    v_mfma_f32_16x16x32_bf16 v[68:71], v[140:143], v[96:99], v[68:71]
    ds_read_b64_tr_b16 v[108:109], v233 offset:18720
    v_mfma_f32_16x16x32_bf16 v[76:79], v[144:147], v[96:99], v[76:79]
    ds_read_b128 v[96:99], v224 offset:20864
    v_mfma_f32_16x16x32_bf16 v[16:19], v[124:127], v[84:87], v[16:19]
    ds_read_b64_tr_b16 v[110:111], v233 offset:21024
    v_mfma_f32_16x16x32_bf16 v[20:23], v[128:131], v[84:87], v[20:23]
    ds_read_b64_tr_b16 v[112:113], v232 offset:18752
    v_mfma_f32_16x16x32_bf16 v[24:27], v[132:135], v[84:87], v[24:27]
    ds_read_b64_tr_b16 v[114:115], v232 offset:21056
    v_mfma_f32_16x16x32_bf16 v[28:31], v[136:139], v[84:87], v[28:31]
    ds_read_b128 v[84:87], v225 offset:2432
    v_mfma_f32_16x16x32_bf16 v[32:35], v[124:127], v[88:91], v[32:35]
    ds_read_b64_tr_b16 v[116:117], v220 offset:18688
    v_mfma_f32_16x16x32_bf16 v[36:39], v[128:131], v[88:91], v[36:39]
    ds_read_b64_tr_b16 v[118:119], v220 offset:20992
    v_mfma_f32_16x16x32_bf16 v[40:43], v[132:135], v[88:91], v[40:43]
    ds_read_b64_tr_b16 v[120:121], v221 offset:18976
    v_mfma_f32_16x16x32_bf16 v[44:47], v[136:139], v[88:91], v[44:47]
    ds_read_b128 v[88:91], v226 offset:2432
    s_waitcnt lgkmcnt(9)
    v_mfma_f32_16x16x32_bf16 v[48:51], v[124:127], v[92:95], v[48:51]
    ds_read_b64_tr_b16 v[122:123], v221 offset:21280
    v_mfma_f32_16x16x32_bf16 v[52:55], v[128:131], v[92:95], v[52:55]
    v_mfma_f32_16x16x32_bf16 v[56:59], v[132:135], v[92:95], v[56:59]
    v_mfma_f32_16x16x32_bf16 v[60:63], v[136:139], v[92:95], v[60:63]
    ds_read_b128 v[92:95], v227 offset:2432
    v_mfma_f32_16x16x32_bf16 v[0:3], v[100:103], v[80:83], v[0:3]
    s_add_u32 m0, s52, 131328
    s_add_u32 s54, s52, 110592
    buffer_load_dwordx4 v236, s[20:23], s54 offen offset:0  lds
    s_mov_b32 exec_hi, 0
    buffer_load_dwordx4 v236, s[20:23], s54 offen offset:1024  lds
    s_mov_b32 exec_hi, -1
    s_mov_b64 exec, 0x3ffffff
    buffer_load_dword v160, v162, s[20:23], 0 offen
    buffer_load_dword v161, v163, s[24:27], 0 offen
    s_mov_b64 exec, -1
L_m_U3:
    s_waitcnt vmcnt(8)
    s_barrier
    v_mfma_f32_16x16x32_bf16 v[4:7], v[104:107], v[80:83], v[4:7]
    ds_read_b64_tr_b16 v[124:125], v232 offset:36864
    s_waitcnt lgkmcnt(10)
    v_mfma_f32_16x16x32_bf16 v[8:11], v[108:111], v[80:83], v[8:11]
    ds_read_b64_tr_b16 v[126:127], v232 offset:39168
    s_waitcnt lgkmcnt(9)
    v_mfma_f32_16x16x32_bf16 v[12:15], v[112:115], v[80:83], v[12:15]
    ds_read_b64_tr_b16 v[128:129], v233 offset:36896
    s_waitcnt lgkmcnt(7)
    v_mfma_f32_16x16x32_bf16 v[64:67], v[116:119], v[80:83], v[64:67]
    ds_read_b64_tr_b16 v[130:131], v233 offset:39200
    s_waitcnt lgkmcnt(5)
    v_mfma_f32_16x16x32_bf16 v[72:75], v[120:123], v[80:83], v[72:75]
    ds_read_b128 v[80:83], v224 offset:2496
    v_mfma_f32_16x16x32_bf16 v[68:71], v[116:119], v[96:99], v[68:71]
    ds_read_b64_tr_b16 v[132:133], v233 offset:37152
    v_mfma_f32_16x16x32_bf16 v[76:79], v[120:123], v[96:99], v[76:79]
    ds_read_b128 v[96:99], v224 offset:20928
    v_mfma_f32_16x16x32_bf16 v[16:19], v[100:103], v[84:87], v[16:19]
    ds_read_b64_tr_b16 v[134:135], v233 offset:39456
    v_mfma_f32_16x16x32_bf16 v[20:23], v[104:107], v[84:87], v[20:23]
    ds_read_b64_tr_b16 v[136:137], v232 offset:37184
    v_mfma_f32_16x16x32_bf16 v[24:27], v[108:111], v[84:87], v[24:27]
    ds_read_b64_tr_b16 v[138:139], v232 offset:39488
    v_mfma_f32_16x16x32_bf16 v[28:31], v[112:115], v[84:87], v[28:31]
    ds_read_b128 v[84:87], v225 offset:2496
    v_mfma_f32_16x16x32_bf16 v[32:35], v[100:103], v[88:91], v[32:35]
    ds_read_b64_tr_b16 v[140:141], v220 offset:37120
    v_mfma_f32_16x16x32_bf16 v[36:39], v[104:107], v[88:91], v[36:39]
    ds_read_b64_tr_b16 v[142:143], v220 offset:39424
    v_mfma_f32_16x16x32_bf16 v[40:43], v[108:111], v[88:91], v[40:43]
    ds_read_b64_tr_b16 v[144:145], v221 offset:37408
    v_mfma_f32_16x16x32_bf16 v[44:47], v[112:115], v[88:91], v[44:47]
    ds_read_b128 v[88:91], v226 offset:2496
    s_waitcnt lgkmcnt(9)
    v_mfma_f32_16x16x32_bf16 v[48:51], v[100:103], v[92:95], v[48:51]
    ds_read_b64_tr_b16 v[146:147], v221 offset:39712
    v_mfma_f32_16x16x32_bf16 v[52:55], v[104:107], v[92:95], v[52:55]
    v_mfma_f32_16x16x32_bf16 v[56:59], v[108:111], v[92:95], v[56:59]
    v_mfma_f32_16x16x32_bf16 v[60:63], v[112:115], v[92:95], v[60:63]
    ds_read_b128 v[92:95], v227 offset:2496
    v_mfma_f32_16x16x32_bf16 v[0:3], v[124:127], v[80:83], v[0:3]
    s_add_u32 m0, s52, 39168
    s_add_u32 s54, s52, 129024
    buffer_load_dwordx4 v236, s[20:23], s54 offen offset:0  lds
    s_mov_b32 exec_hi, 0
    buffer_load_dwordx4 v236, s[20:23], s54 offen offset:1024  lds
    s_mov_b32 exec_hi, -1
L_m_U4:
    s_waitcnt vmcnt(8)
    s_barrier
    v_mfma_f32_16x16x32_bf16 v[4:7], v[128:131], v[80:83], v[4:7]
    ds_read_b64_tr_b16 v[100:101], v234 offset:0
    s_waitcnt lgkmcnt(10)
    v_mfma_f32_16x16x32_bf16 v[8:11], v[132:135], v[80:83], v[8:11]
    ds_read_b64_tr_b16 v[102:103], v234 offset:2304
    s_waitcnt lgkmcnt(9)
    v_mfma_f32_16x16x32_bf16 v[12:15], v[136:139], v[80:83], v[12:15]
    ds_read_b64_tr_b16 v[104:105], v235 offset:32
    s_waitcnt lgkmcnt(7)
    v_mfma_f32_16x16x32_bf16 v[64:67], v[140:143], v[80:83], v[64:67]
    ds_read_b64_tr_b16 v[106:107], v235 offset:2336
    s_waitcnt lgkmcnt(5)
    v_mfma_f32_16x16x32_bf16 v[72:75], v[144:147], v[80:83], v[72:75]
    ds_read_b128 v[80:83], v228 offset:1728
    v_mfma_f32_16x16x32_bf16 v[68:71], v[140:143], v[96:99], v[68:71]
    ds_read_b64_tr_b16 v[108:109], v235 offset:288
    v_mfma_f32_16x16x32_bf16 v[76:79], v[144:147], v[96:99], v[76:79]
    ds_read_b128 v[96:99], v228 offset:20160
    v_mfma_f32_16x16x32_bf16 v[16:19], v[124:127], v[84:87], v[16:19]
    ds_read_b64_tr_b16 v[110:111], v235 offset:2592
    v_mfma_f32_16x16x32_bf16 v[20:23], v[128:131], v[84:87], v[20:23]
    ds_read_b64_tr_b16 v[112:113], v234 offset:320
    v_mfma_f32_16x16x32_bf16 v[24:27], v[132:135], v[84:87], v[24:27]
    ds_read_b64_tr_b16 v[114:115], v234 offset:2624
    v_mfma_f32_16x16x32_bf16 v[28:31], v[136:139], v[84:87], v[28:31]
    ds_read_b128 v[84:87], v229 offset:1728
    v_mfma_f32_16x16x32_bf16 v[32:35], v[124:127], v[88:91], v[32:35]
    ds_read_b64_tr_b16 v[116:117], v222 offset:256
    v_mfma_f32_16x16x32_bf16 v[36:39], v[128:131], v[88:91], v[36:39]
    ds_read_b64_tr_b16 v[118:119], v222 offset:2560
    v_mfma_f32_16x16x32_bf16 v[40:43], v[132:135], v[88:91], v[40:43]
    ds_read_b64_tr_b16 v[120:121], v223 offset:544
    v_mfma_f32_16x16x32_bf16 v[44:47], v[136:139], v[88:91], v[44:47]
    ds_read_b128 v[88:91], v230 offset:1728
    s_waitcnt lgkmcnt(9)
    v_mfma_f32_16x16x32_bf16 v[48:51], v[124:127], v[92:95], v[48:51]
    ds_read_b64_tr_b16 v[122:123], v223 offset:2848
    v_mfma_f32_16x16x32_bf16 v[52:55], v[128:131], v[92:95], v[52:55]
    v_mfma_f32_16x16x32_bf16 v[56:59], v[132:135], v[92:95], v[56:59]
    v_mfma_f32_16x16x32_bf16 v[60:63], v[136:139], v[92:95], v[60:63]
    ds_read_b128 v[92:95], v231 offset:1728
    v_mfma_f32_16x16x32_bf16 v[0:3], v[100:103], v[80:83], v[0:3]
    s_add_u32 m0, s52, 57600
    s_add_u32 s54, s52, 147456
    buffer_load_dwordx4 v236, s[20:23], s54 offen offset:0  lds
    s_mov_b32 exec_hi, 0
    buffer_load_dwordx4 v236, s[20:23], s54 offen offset:1024  lds
    s_mov_b32 exec_hi, -1
L_m_U5:
    s_waitcnt vmcnt(8)
    s_barrier
    v_mfma_f32_16x16x32_bf16 v[4:7], v[104:107], v[80:83], v[4:7]
    ds_read_b64_tr_b16 v[124:125], v234 offset:18432
    s_waitcnt lgkmcnt(10)
    v_mfma_f32_16x16x32_bf16 v[8:11], v[108:111], v[80:83], v[8:11]
    ds_read_b64_tr_b16 v[126:127], v234 offset:20736
    s_waitcnt lgkmcnt(9)
    v_mfma_f32_16x16x32_bf16 v[12:15], v[112:115], v[80:83], v[12:15]
    ds_read_b64_tr_b16 v[128:129], v235 offset:18464
    s_waitcnt lgkmcnt(7)
    v_mfma_f32_16x16x32_bf16 v[64:67], v[116:119], v[80:83], v[64:67]
    ds_read_b64_tr_b16 v[130:131], v235 offset:20768
    s_waitcnt lgkmcnt(5)
    v_mfma_f32_16x16x32_bf16 v[72:75], v[120:123], v[80:83], v[72:75]
    ds_read_b128 v[80:83], v224 offset:1760
    v_mfma_f32_16x16x32_bf16 v[68:71], v[116:119], v[96:99], v[68:71]
    ds_read_b64_tr_b16 v[132:133], v235 offset:18720
    v_mfma_f32_16x16x32_bf16 v[76:79], v[120:123], v[96:99], v[76:79]
    ds_read_b128 v[96:99], v224 offset:20192
    v_mfma_f32_16x16x32_bf16 v[16:19], v[100:103], v[84:87], v[16:19]
    ds_read_b64_tr_b16 v[134:135], v235 offset:21024
    v_mfma_f32_16x16x32_bf16 v[20:23], v[104:107], v[84:87], v[20:23]
    ds_read_b64_tr_b16 v[136:137], v234 offset:18752
    v_mfma_f32_16x16x32_bf16 v[24:27], v[108:111], v[84:87], v[24:27]
    ds_read_b64_tr_b16 v[138:139], v234 offset:21056
    v_mfma_f32_16x16x32_bf16 v[28:31], v[112:115], v[84:87], v[28:31]
    ds_read_b128 v[84:87], v225 offset:1760
    v_mfma_f32_16x16x32_bf16 v[32:35], v[100:103], v[88:91], v[32:35]
    ds_read_b64_tr_b16 v[140:141], v222 offset:18688
    v_mfma_f32_16x16x32_bf16 v[36:39], v[104:107], v[88:91], v[36:39]
    ds_read_b64_tr_b16 v[142:143], v222 offset:20992
    v_mfma_f32_16x16x32_bf16 v[40:43], v[108:111], v[88:91], v[40:43]
    ds_read_b64_tr_b16 v[144:145], v223 offset:18976
    v_mfma_f32_16x16x32_bf16 v[44:47], v[112:115], v[88:91], v[44:47]
    ds_read_b128 v[88:91], v226 offset:1760
    s_waitcnt lgkmcnt(9)
    v_mfma_f32_16x16x32_bf16 v[48:51], v[100:103], v[92:95], v[48:51]
    ds_read_b64_tr_b16 v[146:147], v223 offset:21280
    v_mfma_f32_16x16x32_bf16 v[52:55], v[104:107], v[92:95], v[52:55]
    v_mfma_f32_16x16x32_bf16 v[56:59], v[108:111], v[92:95], v[56:59]
    v_mfma_f32_16x16x32_bf16 v[60:63], v[112:115], v[92:95], v[60:63]
    ds_read_b128 v[92:95], v227 offset:1760
    v_mfma_f32_16x16x32_bf16 v[0:3], v[124:127], v[80:83], v[0:3]
    s_add_u32 m0, s52, 76032
    s_add_u32 s54, s52, 165888
    buffer_load_dwordx4 v236, s[20:23], s54 offen offset:0  lds
    s_mov_b32 exec_hi, 0
    buffer_load_dwordx4 v236, s[20:23], s54 offen offset:1024  lds
    s_mov_b32 exec_hi, -1
L_m_U6:
    s_waitcnt vmcnt(8)
    s_barrier
    v_mfma_f32_16x16x32_bf16 v[4:7], v[128:131], v[80:83], v[4:7]
    ds_read_b64_tr_b16 v[100:101], v234 offset:36864
    s_waitcnt lgkmcnt(10)
    v_mfma_f32_16x16x32_bf16 v[8:11], v[132:135], v[80:83], v[8:11]
    ds_read_b64_tr_b16 v[102:103], v234 offset:39168
    s_waitcnt lgkmcnt(9)
    v_mfma_f32_16x16x32_bf16 v[12:15], v[136:139], v[80:83], v[12:15]
    ds_read_b64_tr_b16 v[104:105], v235 offset:36896
    s_waitcnt lgkmcnt(7)
    v_mfma_f32_16x16x32_bf16 v[64:67], v[140:143], v[80:83], v[64:67]
    ds_read_b64_tr_b16 v[106:107], v235 offset:39200
    s_waitcnt lgkmcnt(5)
    v_mfma_f32_16x16x32_bf16 v[72:75], v[144:147], v[80:83], v[72:75]
    ds_read_b128 v[80:83], v224 offset:1824
    v_mfma_f32_16x16x32_bf16 v[68:71], v[140:143], v[96:99], v[68:71]
    ds_read_b64_tr_b16 v[108:109], v235 offset:37152
    v_mfma_f32_16x16x32_bf16 v[76:79], v[144:147], v[96:99], v[76:79]
    ds_read_b128 v[96:99], v224 offset:20256
    v_mfma_f32_16x16x32_bf16 v[16:19], v[124:127], v[84:87], v[16:19]
    ds_read_b64_tr_b16 v[110:111], v235 offset:39456
    v_mfma_f32_16x16x32_bf16 v[20:23], v[128:131], v[84:87], v[20:23]
    ds_read_b64_tr_b16 v[112:113], v234 offset:37184
    v_mfma_f32_16x16x32_bf16 v[24:27], v[132:135], v[84:87], v[24:27]
    ds_read_b64_tr_b16 v[114:115], v234 offset:39488
    v_mfma_f32_16x16x32_bf16 v[28:31], v[136:139], v[84:87], v[28:31]
    ds_read_b128 v[84:87], v225 offset:1824
    v_mfma_f32_16x16x32_bf16 v[32:35], v[124:127], v[88:91], v[32:35]
    ds_read_b64_tr_b16 v[116:117], v222 offset:37120
    v_mfma_f32_16x16x32_bf16 v[36:39], v[128:131], v[88:91], v[36:39]
    ds_read_b64_tr_b16 v[118:119], v222 offset:39424
    v_mfma_f32_16x16x32_bf16 v[40:43], v[132:135], v[88:91], v[40:43]
    ds_read_b64_tr_b16 v[120:121], v223 offset:37408
    v_mfma_f32_16x16x32_bf16 v[44:47], v[136:139], v[88:91], v[44:47]
    ds_read_b128 v[88:91], v226 offset:1824
    s_waitcnt lgkmcnt(9)
    v_mfma_f32_16x16x32_bf16 v[48:51], v[124:127], v[92:95], v[48:51]
    ds_read_b64_tr_b16 v[122:123], v223 offset:39712
    v_mfma_f32_16x16x32_bf16 v[52:55], v[128:131], v[92:95], v[52:55]
    v_mfma_f32_16x16x32_bf16 v[56:59], v[132:135], v[92:95], v[56:59]
    v_mfma_f32_16x16x32_bf16 v[60:63], v[136:139], v[92:95], v[60:63]
    ds_read_b128 v[92:95], v227 offset:1824
    v_mfma_f32_16x16x32_bf16 v[0:3], v[100:103], v[80:83], v[0:3]
    s_add_u32 m0, s52, 94464
    s_add_u32 s54, s52, 184320
    buffer_load_dwordx4 v236, s[20:23], s54 offen offset:0  lds
    s_mov_b32 exec_hi, 0
    buffer_load_dwordx4 v236, s[20:23], s54 offen offset:1024  lds
    s_mov_b32 exec_hi, -1
L_m_U7:
    s_waitcnt vmcnt(6)
    s_barrier
    v_mfma_f32_16x16x32_bf16 v[4:7], v[104:107], v[80:83], v[4:7]
    ds_read_b64_tr_b16 v[124:125], v232 offset:0
    s_waitcnt lgkmcnt(10)
    v_mfma_f32_16x16x32_bf16 v[8:11], v[108:111], v[80:83], v[8:11]
    ds_read_b64_tr_b16 v[126:127], v232 offset:2304
    s_waitcnt lgkmcnt(9)
    v_mfma_f32_16x16x32_bf16 v[12:15], v[112:115], v[80:83], v[12:15]
    ds_read_b64_tr_b16 v[128:129], v233 offset:32
    s_waitcnt lgkmcnt(7)
    v_mfma_f32_16x16x32_bf16 v[64:67], v[116:119], v[80:83], v[64:67]
    ds_read_b64_tr_b16 v[130:131], v233 offset:2336
    s_waitcnt lgkmcnt(5)
    v_mfma_f32_16x16x32_bf16 v[72:75], v[120:123], v[80:83], v[72:75]
    ds_read_b128 v[80:83], v224 offset:1888
    v_mfma_f32_16x16x32_bf16 v[68:71], v[116:119], v[96:99], v[68:71]
    ds_read_b64_tr_b16 v[132:133], v233 offset:288
    v_mfma_f32_16x16x32_bf16 v[76:79], v[120:123], v[96:99], v[76:79]
    ds_read_b128 v[96:99], v224 offset:20320
    v_mfma_f32_16x16x32_bf16 v[16:19], v[100:103], v[84:87], v[16:19]
    ds_read_b64_tr_b16 v[134:135], v233 offset:2592
    v_mfma_f32_16x16x32_bf16 v[20:23], v[104:107], v[84:87], v[20:23]
    ds_read_b64_tr_b16 v[136:137], v232 offset:320
    v_mfma_f32_16x16x32_bf16 v[24:27], v[108:111], v[84:87], v[24:27]
    ds_read_b64_tr_b16 v[138:139], v232 offset:2624
    v_mfma_f32_16x16x32_bf16 v[28:31], v[112:115], v[84:87], v[28:31]
    ds_read_b128 v[84:87], v225 offset:1888
    v_mfma_f32_16x16x32_bf16 v[32:35], v[100:103], v[88:91], v[32:35]
    ds_read_b64_tr_b16 v[140:141], v220 offset:256
    v_mfma_f32_16x16x32_bf16 v[36:39], v[104:107], v[88:91], v[36:39]
    ds_read_b64_tr_b16 v[142:143], v220 offset:2560
    v_mfma_f32_16x16x32_bf16 v[40:43], v[108:111], v[88:91], v[40:43]
    ds_read_b64_tr_b16 v[144:145], v221 offset:544
    v_mfma_f32_16x16x32_bf16 v[44:47], v[112:115], v[88:91], v[44:47]
    ds_read_b128 v[88:91], v226 offset:1888
    s_waitcnt lgkmcnt(9)
    v_mfma_f32_16x16x32_bf16 v[48:51], v[100:103], v[92:95], v[48:51]
    ds_read_b64_tr_b16 v[146:147], v221 offset:2848
    v_mfma_f32_16x16x32_bf16 v[52:55], v[104:107], v[92:95], v[52:55]
    v_mfma_f32_16x16x32_bf16 v[56:59], v[108:111], v[92:95], v[56:59]
    v_mfma_f32_16x16x32_bf16 v[60:63], v[112:115], v[92:95], v[60:63]
    ds_read_b128 v[92:95], v227 offset:1888
    v_mfma_f32_16x16x32_bf16 v[0:3], v[124:127], v[80:83], v[0:3]
    s_add_u32 m0, s52, 112896
    s_add_u32 s54, s52, 202752
    buffer_load_dwordx4 v236, s[20:23], s54 offen offset:0  lds
    s_mov_b32 exec_hi, 0
    buffer_load_dwordx4 v236, s[20:23], s54 offen offset:1024  lds
    s_mov_b32 exec_hi, -1
L_m_U8:
    s_waitcnt vmcnt(6)
    s_barrier
    v_mfma_f32_16x16x32_bf16 v[4:7], v[128:131], v[80:83], v[4:7]
    ds_read_b64_tr_b16 v[100:101], v232 offset:18432
    s_waitcnt lgkmcnt(10)
    v_mfma_f32_16x16x32_bf16 v[8:11], v[132:135], v[80:83], v[8:11]
    ds_read_b64_tr_b16 v[102:103], v232 offset:20736
    s_waitcnt lgkmcnt(9)
    v_mfma_f32_16x16x32_bf16 v[12:15], v[136:139], v[80:83], v[12:15]
    ds_read_b64_tr_b16 v[104:105], v233 offset:18464
    s_waitcnt lgkmcnt(7)
    v_mfma_f32_16x16x32_bf16 v[64:67], v[140:143], v[80:83], v[64:67]
    ds_read_b64_tr_b16 v[106:107], v233 offset:20768
    s_waitcnt lgkmcnt(5)
    v_mfma_f32_16x16x32_bf16 v[72:75], v[144:147], v[80:83], v[72:75]
    ds_read_b128 v[80:83], v224 offset:1952
    v_mfma_f32_16x16x32_bf16 v[68:71], v[140:143], v[96:99], v[68:71]
    ds_read_b64_tr_b16 v[108:109], v233 offset:18720
    v_mfma_f32_16x16x32_bf16 v[76:79], v[144:147], v[96:99], v[76:79]
    ds_read_b128 v[96:99], v224 offset:20384
    v_mfma_f32_16x16x32_bf16 v[16:19], v[124:127], v[84:87], v[16:19]
    ds_read_b64_tr_b16 v[110:111], v233 offset:21024
    v_mfma_f32_16x16x32_bf16 v[20:23], v[128:131], v[84:87], v[20:23]
    ds_read_b64_tr_b16 v[112:113], v232 offset:18752
    v_mfma_f32_16x16x32_bf16 v[24:27], v[132:135], v[84:87], v[24:27]
    ds_read_b64_tr_b16 v[114:115], v232 offset:21056
    v_mfma_f32_16x16x32_bf16 v[28:31], v[136:139], v[84:87], v[28:31]
    ds_read_b128 v[84:87], v225 offset:1952
    v_mfma_f32_16x16x32_bf16 v[32:35], v[124:127], v[88:91], v[32:35]
    ds_read_b64_tr_b16 v[116:117], v220 offset:18688
    v_mfma_f32_16x16x32_bf16 v[36:39], v[128:131], v[88:91], v[36:39]
    ds_read_b64_tr_b16 v[118:119], v220 offset:20992
    v_mfma_f32_16x16x32_bf16 v[40:43], v[132:135], v[88:91], v[40:43]
    ds_read_b64_tr_b16 v[120:121], v221 offset:18976
    v_mfma_f32_16x16x32_bf16 v[44:47], v[136:139], v[88:91], v[44:47]
    ds_read_b128 v[88:91], v226 offset:1952
    s_waitcnt lgkmcnt(9)
    v_mfma_f32_16x16x32_bf16 v[48:51], v[124:127], v[92:95], v[48:51]
    ds_read_b64_tr_b16 v[122:123], v221 offset:21280
    v_mfma_f32_16x16x32_bf16 v[52:55], v[128:131], v[92:95], v[52:55]
    v_mfma_f32_16x16x32_bf16 v[56:59], v[132:135], v[92:95], v[56:59]
    v_mfma_f32_16x16x32_bf16 v[60:63], v[136:139], v[92:95], v[60:63]
    ds_read_b128 v[92:95], v227 offset:1952
    v_mfma_f32_16x16x32_bf16 v[0:3], v[100:103], v[80:83], v[0:3]
    s_add_u32 m0, s52, 131328
    s_add_u32 s54, s52, 221184
    buffer_load_dwordx4 v236, s[20:23], s54 offen offset:0  lds
    s_mov_b32 exec_hi, 0
    buffer_load_dwordx4 v236, s[20:23], s54 offen offset:1024  lds
    s_mov_b32 exec_hi, -1
L_m_U9:
    s_waitcnt vmcnt(6)
    s_barrier
    v_mfma_f32_16x16x32_bf16 v[4:7], v[104:107], v[80:83], v[4:7]
    ds_read_b64_tr_b16 v[124:125], v232 offset:36864
    s_waitcnt lgkmcnt(10)
    v_mfma_f32_16x16x32_bf16 v[8:11], v[108:111], v[80:83], v[8:11]
    ds_read_b64_tr_b16 v[126:127], v232 offset:39168
    s_waitcnt lgkmcnt(9)
    v_mfma_f32_16x16x32_bf16 v[12:15], v[112:115], v[80:83], v[12:15]
L_wp0:
    s_cbranch_execz L_wback
    ds_read_b64_tr_b16 v[128:129], v233 offset:36896
    s_waitcnt lgkmcnt(7)
    v_mfma_f32_16x16x32_bf16 v[64:67], v[116:119], v[80:83], v[64:67]
    ds_read_b64_tr_b16 v[130:131], v233 offset:39200
    s_waitcnt lgkmcnt(5)
    v_mfma_f32_16x16x32_bf16 v[72:75], v[120:123], v[80:83], v[72:75]
    ds_read_b128 v[80:83], v224 offset:1152
    v_mfma_f32_16x16x32_bf16 v[68:71], v[116:119], v[96:99], v[68:71]
    ds_read_b64_tr_b16 v[132:133], v233 offset:37152
    v_mfma_f32_16x16x32_bf16 v[76:79], v[120:123], v[96:99], v[76:79]
    ds_read_b128 v[96:99], v224 offset:19584
    v_mfma_f32_16x16x32_bf16 v[16:19], v[100:103], v[84:87], v[16:19]
    ds_read_b64_tr_b16 v[134:135], v233 offset:39456
    v_mfma_f32_16x16x32_bf16 v[20:23], v[104:107], v[84:87], v[20:23]
    ds_read_b64_tr_b16 v[136:137], v232 offset:37184
    v_mfma_f32_16x16x32_bf16 v[24:27], v[108:111], v[84:87], v[24:27]
    ds_read_b64_tr_b16 v[138:139], v232 offset:39488
    v_mfma_f32_16x16x32_bf16 v[28:31], v[112:115], v[84:87], v[28:31]
    ds_read_b128 v[84:87], v225 offset:1152
    v_mfma_f32_16x16x32_bf16 v[32:35], v[100:103], v[88:91], v[32:35]
    ds_read_b64_tr_b16 v[140:141], v220 offset:37120
    v_mfma_f32_16x16x32_bf16 v[36:39], v[104:107], v[88:91], v[36:39]
    ds_read_b64_tr_b16 v[142:143], v220 offset:39424
    v_mfma_f32_16x16x32_bf16 v[40:43], v[108:111], v[88:91], v[40:43]
    ds_read_b64_tr_b16 v[144:145], v221 offset:37408
    v_mfma_f32_16x16x32_bf16 v[44:47], v[112:115], v[88:91], v[44:47]
    ds_read_b128 v[88:91], v226 offset:1152
    s_waitcnt lgkmcnt(9)
    v_mfma_f32_16x16x32_bf16 v[48:51], v[100:103], v[92:95], v[48:51]
    ds_read_b64_tr_b16 v[146:147], v221 offset:39712
    v_mfma_f32_16x16x32_bf16 v[52:55], v[104:107], v[92:95], v[52:55]
    v_mfma_f32_16x16x32_bf16 v[56:59], v[108:111], v[92:95], v[56:59]
    v_mfma_f32_16x16x32_bf16 v[60:63], v[112:115], v[92:95], v[60:63]
    ds_read_b128 v[92:95], v227 offset:1152
    v_mfma_f32_16x16x32_bf16 v[0:3], v[124:127], v[80:83], v[0:3]
    s_add_u32 m0, s52, 39168
    s_add_u32 s54, s52, 239616
    buffer_load_dwordx4 v236, s[20:23], s54 offen offset:0  lds
    s_mov_b32 exec_hi, 0
    buffer_load_dwordx4 v236, s[20:23], s54 offen offset:1024  lds
    s_mov_b32 exec_hi, -1
L_m_U10:
    s_waitcnt vmcnt(6)
    s_barrier
    v_mfma_f32_16x16x32_bf16 v[4:7], v[128:131], v[80:83], v[4:7]
    ds_read_b64_tr_b16 v[100:101], v234 offset:0
    s_waitcnt lgkmcnt(10)
    v_mfma_f32_16x16x32_bf16 v[8:11], v[132:135], v[80:83], v[8:11]
    ds_read_b64_tr_b16 v[102:103], v234 offset:2304
    s_waitcnt lgkmcnt(9)
    v_mfma_f32_16x16x32_bf16 v[12:15], v[136:139], v[80:83], v[12:15]
    ds_read_b64_tr_b16 v[104:105], v235 offset:32
    s_waitcnt lgkmcnt(7)
    v_mfma_f32_16x16x32_bf16 v[64:67], v[140:143], v[80:83], v[64:67]
    ds_read_b64_tr_b16 v[106:107], v235 offset:2336
    s_waitcnt lgkmcnt(5)
    v_mfma_f32_16x16x32_bf16 v[72:75], v[144:147], v[80:83], v[72:75]
    ds_read_b128 v[80:83], v224 offset:1216
    v_mfma_f32_16x16x32_bf16 v[68:71], v[140:143], v[96:99], v[68:71]
    ds_read_b64_tr_b16 v[108:109], v235 offset:288
    v_mfma_f32_16x16x32_bf16 v[76:79], v[144:147], v[96:99], v[76:79]
    ds_read_b128 v[96:99], v224 offset:19648
    v_mfma_f32_16x16x32_bf16 v[16:19], v[124:127], v[84:87], v[16:19]
    ds_read_b64_tr_b16 v[110:111], v235 offset:2592
    v_mfma_f32_16x16x32_bf16 v[20:23], v[128:131], v[84:87], v[20:23]
    ds_read_b64_tr_b16 v[112:113], v234 offset:320
    v_mfma_f32_16x16x32_bf16 v[24:27], v[132:135], v[84:87], v[24:27]
    ds_read_b64_tr_b16 v[114:115], v234 offset:2624
    v_mfma_f32_16x16x32_bf16 v[28:31], v[136:139], v[84:87], v[28:31]
    ds_read_b128 v[84:87], v225 offset:1216
    v_mfma_f32_16x16x32_bf16 v[32:35], v[124:127], v[88:91], v[32:35]
    ds_read_b64_tr_b16 v[116:117], v222 offset:256
    v_mfma_f32_16x16x32_bf16 v[36:39], v[128:131], v[88:91], v[36:39]
    ds_read_b64_tr_b16 v[118:119], v222 offset:2560
    v_mfma_f32_16x16x32_bf16 v[40:43], v[132:135], v[88:91], v[40:43]
    ds_read_b64_tr_b16 v[120:121], v223 offset:544
    v_mfma_f32_16x16x32_bf16 v[44:47], v[136:139], v[88:91], v[44:47]
    ds_read_b128 v[88:91], v226 offset:1216
    s_waitcnt lgkmcnt(9)
    v_mfma_f32_16x16x32_bf16 v[48:51], v[124:127], v[92:95], v[48:51]
    ds_read_b64_tr_b16 v[122:123], v223 offset:2848
    v_mfma_f32_16x16x32_bf16 v[52:55], v[128:131], v[92:95], v[52:55]
    v_mfma_f32_16x16x32_bf16 v[56:59], v[132:135], v[92:95], v[56:59]
    v_mfma_f32_16x16x32_bf16 v[60:63], v[136:139], v[92:95], v[60:63]
    ds_read_b128 v[92:95], v227 offset:1216
    v_mfma_f32_16x16x32_bf16 v[0:3], v[100:103], v[80:83], v[0:3]
    s_add_u32 m0, s52, 57600
    s_add_u32 s54, s52, 258048
    buffer_load_dwordx4 v236, s[20:23], s54 offen offset:0  lds
    s_mov_b32 exec_hi, 0
    buffer_load_dwordx4 v236, s[20:23], s54 offen offset:1024  lds
    s_mov_b32 exec_hi, -1
L_m_U11:
    s_waitcnt vmcnt(6)
    s_barrier
    v_mfma_f32_16x16x32_bf16 v[4:7], v[104:107], v[80:83], v[4:7]
    ds_read_b64_tr_b16 v[124:125], v234 offset:18432
    s_waitcnt lgkmcnt(10)
    v_mfma_f32_16x16x32_bf16 v[8:11], v[108:111], v[80:83], v[8:11]
    ds_read_b64_tr_b16 v[126:127], v234 offset:20736
    s_waitcnt lgkmcnt(9)
    v_mfma_f32_16x16x32_bf16 v[12:15], v[112:115], v[80:83], v[12:15]
    ds_read_b64_tr_b16 v[128:129], v235 offset:18464
    s_waitcnt lgkmcnt(7)
    v_mfma_f32_16x16x32_bf16 v[64:67], v[116:119], v[80:83], v[64:67]
    ds_read_b64_tr_b16 v[130:131], v235 offset:20768
    s_waitcnt lgkmcnt(5)
    v_mfma_f32_16x16x32_bf16 v[72:75], v[120:123], v[80:83], v[72:75]
    ds_read_b128 v[80:83], v224 offset:1280
    v_mfma_f32_16x16x32_bf16 v[68:71], v[116:119], v[96:99], v[68:71]
    ds_read_b64_tr_b16 v[132:133], v235 offset:18720
    v_mfma_f32_16x16x32_bf16 v[76:79], v[120:123], v[96:99], v[76:79]
    ds_read_b128 v[96:99], v224 offset:19712
    v_mfma_f32_16x16x32_bf16 v[16:19], v[100:103], v[84:87], v[16:19]
    ds_read_b64_tr_b16 v[134:135], v235 offset:21024
    v_mfma_f32_16x16x32_bf16 v[20:23], v[104:107], v[84:87], v[20:23]
    ds_read_b64_tr_b16 v[136:137], v234 offset:18752
    v_mfma_f32_16x16x32_bf16 v[24:27], v[108:111], v[84:87], v[24:27]
    ds_read_b64_tr_b16 v[138:139], v234 offset:21056
    v_mfma_f32_16x16x32_bf16 v[28:31], v[112:115], v[84:87], v[28:31]
    ds_read_b128 v[84:87], v225 offset:1280
    v_mfma_f32_16x16x32_bf16 v[32:35], v[100:103], v[88:91], v[32:35]
    ds_read_b64_tr_b16 v[140:141], v222 offset:18688
    v_mfma_f32_16x16x32_bf16 v[36:39], v[104:107], v[88:91], v[36:39]
    ds_read_b64_tr_b16 v[142:143], v222 offset:20992
    v_mfma_f32_16x16x32_bf16 v[40:43], v[108:111], v[88:91], v[40:43]
    ds_read_b64_tr_b16 v[144:145], v223 offset:18976
    v_mfma_f32_16x16x32_bf16 v[44:47], v[112:115], v[88:91], v[44:47]
    ds_read_b128 v[88:91], v226 offset:1280
    s_waitcnt lgkmcnt(9)
    v_mfma_f32_16x16x32_bf16 v[48:51], v[100:103], v[92:95], v[48:51]
    ds_read_b64_tr_b16 v[146:147], v223 offset:21280
    v_mfma_f32_16x16x32_bf16 v[52:55], v[104:107], v[92:95], v[52:55]
    v_mfma_f32_16x16x32_bf16 v[56:59], v[108:111], v[92:95], v[56:59]
    v_mfma_f32_16x16x32_bf16 v[60:63], v[112:115], v[92:95], v[60:63]
    ds_read_b128 v[92:95], v227 offset:1280
    v_mfma_f32_16x16x32_bf16 v[0:3], v[124:127], v[80:83], v[0:3]
    s_add_u32 m0, s52, 76032
    s_add_u32 s54, s52, 276480
    buffer_load_dwordx4 v236, s[20:23], s54 offen offset:0  lds
    s_mov_b32 exec_hi, 0
    buffer_load_dwordx4 v236, s[20:23], s54 offen offset:1024  lds
    s_mov_b32 exec_hi, -1
L_m_U12:
    s_waitcnt vmcnt(6)
    s_barrier
    v_mfma_f32_16x16x32_bf16 v[4:7], v[128:131], v[80:83], v[4:7]
    ds_read_b64_tr_b16 v[100:101], v234 offset:36864
    s_waitcnt lgkmcnt(10)
    v_mfma_f32_16x16x32_bf16 v[8:11], v[132:135], v[80:83], v[8:11]
    ds_read_b64_tr_b16 v[102:103], v234 offset:39168
    s_waitcnt lgkmcnt(9)
    v_mfma_f32_16x16x32_bf16 v[12:15], v[136:139], v[80:83], v[12:15]
    ds_read_b64_tr_b16 v[104:105], v235 offset:36896
    s_waitcnt lgkmcnt(7)
    v_mfma_f32_16x16x32_bf16 v[64:67], v[140:143], v[80:83], v[64:67]
    ds_read_b64_tr_b16 v[106:107], v235 offset:39200
    s_waitcnt lgkmcnt(5)
    v_mfma_f32_16x16x32_bf16 v[72:75], v[144:147], v[80:83], v[72:75]
    ds_read_b128 v[80:83], v224 offset:1344
    v_mfma_f32_16x16x32_bf16 v[68:71], v[140:143], v[96:99], v[68:71]
    ds_read_b64_tr_b16 v[108:109], v235 offset:37152
    v_mfma_f32_16x16x32_bf16 v[76:79], v[144:147], v[96:99], v[76:79]
    ds_read_b128 v[96:99], v224 offset:19776
    v_mfma_f32_16x16x32_bf16 v[16:19], v[124:127], v[84:87], v[16:19]
    ds_read_b64_tr_b16 v[110:111], v235 offset:39456
    v_mfma_f32_16x16x32_bf16 v[20:23], v[128:131], v[84:87], v[20:23]
    ds_read_b64_tr_b16 v[112:113], v234 offset:37184
    v_mfma_f32_16x16x32_bf16 v[24:27], v[132:135], v[84:87], v[24:27]
    ds_read_b64_tr_b16 v[114:115], v234 offset:39488
    v_mfma_f32_16x16x32_bf16 v[28:31], v[136:139], v[84:87], v[28:31]
    ds_read_b128 v[84:87], v225 offset:1344
    v_mfma_f32_16x16x32_bf16 v[32:35], v[124:127], v[88:91], v[32:35]
    ds_read_b64_tr_b16 v[116:117], v222 offset:37120
    v_mfma_f32_16x16x32_bf16 v[36:39], v[128:131], v[88:91], v[36:39]
    ds_read_b64_tr_b16 v[118:119], v222 offset:39424
    v_mfma_f32_16x16x32_bf16 v[40:43], v[132:135], v[88:91], v[40:43]
    ds_read_b64_tr_b16 v[120:121], v223 offset:37408
    v_mfma_f32_16x16x32_bf16 v[44:47], v[136:139], v[88:91], v[44:47]
    ds_read_b128 v[88:91], v226 offset:1344
    s_waitcnt lgkmcnt(9)
    v_mfma_f32_16x16x32_bf16 v[48:51], v[124:127], v[92:95], v[48:51]
    ds_read_b64_tr_b16 v[122:123], v223 offset:39712
    v_mfma_f32_16x16x32_bf16 v[52:55], v[128:131], v[92:95], v[52:55]
    v_mfma_f32_16x16x32_bf16 v[56:59], v[132:135], v[92:95], v[56:59]
    v_mfma_f32_16x16x32_bf16 v[60:63], v[136:139], v[92:95], v[60:63]
    ds_read_b128 v[92:95], v227 offset:1344
    v_mfma_f32_16x16x32_bf16 v[0:3], v[100:103], v[80:83], v[0:3]
    s_add_u32 m0, s52, 94464
    s_add_u32 s54, s52, 294912
    buffer_load_dwordx4 v236, s[20:23], s54 offen offset:0  lds
    s_mov_b32 exec_hi, 0
    buffer_load_dwordx4 v236, s[20:23], s54 offen offset:1024  lds
    s_mov_b32 exec_hi, -1
L_m_U13:
    s_waitcnt vmcnt(6)
    s_barrier
    v_mfma_f32_16x16x32_bf16 v[4:7], v[104:107], v[80:83], v[4:7]
    ds_read_b64_tr_b16 v[124:125], v232 offset:0
    s_waitcnt lgkmcnt(10)
    v_mfma_f32_16x16x32_bf16 v[8:11], v[108:111], v[80:83], v[8:11]
    ds_read_b64_tr_b16 v[126:127], v232 offset:2304
    s_waitcnt lgkmcnt(9)
    v_mfma_f32_16x16x32_bf16 v[12:15], v[112:115], v[80:83], v[12:15]
    ds_read_b64_tr_b16 v[128:129], v233 offset:32
    s_waitcnt lgkmcnt(7)
    v_mfma_f32_16x16x32_bf16 v[64:67], v[116:119], v[80:83], v[64:67]
    ds_read_b64_tr_b16 v[130:131], v233 offset:2336
    s_waitcnt lgkmcnt(5)
    v_mfma_f32_16x16x32_bf16 v[72:75], v[120:123], v[80:83], v[72:75]
    ds_read_b128 v[80:83], v228 offset:576
    v_mfma_f32_16x16x32_bf16 v[68:71], v[116:119], v[96:99], v[68:71]
    ds_read_b64_tr_b16 v[132:133], v233 offset:288
    v_mfma_f32_16x16x32_bf16 v[76:79], v[120:123], v[96:99], v[76:79]
    ds_read_b128 v[96:99], v228 offset:19008
    v_mfma_f32_16x16x32_bf16 v[16:19], v[100:103], v[84:87], v[16:19]
    ds_read_b64_tr_b16 v[134:135], v233 offset:2592
    v_mfma_f32_16x16x32_bf16 v[20:23], v[104:107], v[84:87], v[20:23]
    ds_read_b64_tr_b16 v[136:137], v232 offset:320
    v_mfma_f32_16x16x32_bf16 v[24:27], v[108:111], v[84:87], v[24:27]
    ds_read_b64_tr_b16 v[138:139], v232 offset:2624
    v_mfma_f32_16x16x32_bf16 v[28:31], v[112:115], v[84:87], v[28:31]
    ds_read_b128 v[84:87], v229 offset:576
    v_mfma_f32_16x16x32_bf16 v[32:35], v[100:103], v[88:91], v[32:35]
    ds_read_b64_tr_b16 v[140:141], v220 offset:256
    v_mfma_f32_16x16x32_bf16 v[36:39], v[104:107], v[88:91], v[36:39]
    ds_read_b64_tr_b16 v[142:143], v220 offset:2560
    v_mfma_f32_16x16x32_bf16 v[40:43], v[108:111], v[88:91], v[40:43]
    ds_read_b64_tr_b16 v[144:145], v221 offset:544
    v_mfma_f32_16x16x32_bf16 v[44:47], v[112:115], v[88:91], v[44:47]
    ds_read_b128 v[88:91], v230 offset:576
    s_waitcnt lgkmcnt(9)
    v_mfma_f32_16x16x32_bf16 v[48:51], v[100:103], v[92:95], v[48:51]
    ds_read_b64_tr_b16 v[146:147], v221 offset:2848
    v_mfma_f32_16x16x32_bf16 v[52:55], v[104:107], v[92:95], v[52:55]
    v_mfma_f32_16x16x32_bf16 v[56:59], v[108:111], v[92:95], v[56:59]
    v_mfma_f32_16x16x32_bf16 v[60:63], v[112:115], v[92:95], v[60:63]
    ds_read_b128 v[92:95], v231 offset:576
    v_mfma_f32_16x16x32_bf16 v[0:3], v[124:127], v[80:83], v[0:3]
    s_add_u32 m0, s52, 112896
    s_add_u32 s54, s52, 313344
    buffer_load_dwordx4 v236, s[20:23], s54 offen offset:0  lds
    s_mov_b32 exec_hi, 0
    buffer_load_dwordx4 v236, s[20:23], s54 offen offset:1024  lds
    s_mov_b32 exec_hi, -1
L_m_U14:
    s_waitcnt vmcnt(6)
    s_barrier
    v_mfma_f32_16x16x32_bf16 v[4:7], v[128:131], v[80:83], v[4:7]
    ds_read_b64_tr_b16 v[100:101], v232 offset:18432
    s_waitcnt lgkmcnt(10)
    v_mfma_f32_16x16x32_bf16 v[8:11], v[132:135], v[80:83], v[8:11]
    ds_read_b64_tr_b16 v[102:103], v232 offset:20736
    s_waitcnt lgkmcnt(9)
    v_mfma_f32_16x16x32_bf16 v[12:15], v[136:139], v[80:83], v[12:15]
    ds_read_b64_tr_b16 v[104:105], v233 offset:18464
    s_waitcnt lgkmcnt(7)
    v_mfma_f32_16x16x32_bf16 v[64:67], v[140:143], v[80:83], v[64:67]
    ds_read_b64_tr_b16 v[106:107], v233 offset:20768
    s_waitcnt lgkmcnt(5)
    v_mfma_f32_16x16x32_bf16 v[72:75], v[144:147], v[80:83], v[72:75]
    ds_read_b128 v[80:83], v224 offset:608
    v_mfma_f32_16x16x32_bf16 v[68:71], v[140:143], v[96:99], v[68:71]
    ds_read_b64_tr_b16 v[108:109], v233 offset:18720
    v_mfma_f32_16x16x32_bf16 v[76:79], v[144:147], v[96:99], v[76:79]
    ds_read_b128 v[96:99], v224 offset:19040
    v_mfma_f32_16x16x32_bf16 v[16:19], v[124:127], v[84:87], v[16:19]
    ds_read_b64_tr_b16 v[110:111], v233 offset:21024
    v_mfma_f32_16x16x32_bf16 v[20:23], v[128:131], v[84:87], v[20:23]
    ds_read_b64_tr_b16 v[112:113], v232 offset:18752
    v_mfma_f32_16x16x32_bf16 v[24:27], v[132:135], v[84:87], v[24:27]
    ds_read_b64_tr_b16 v[114:115], v232 offset:21056
    v_mfma_f32_16x16x32_bf16 v[28:31], v[136:139], v[84:87], v[28:31]
    ds_read_b128 v[84:87], v225 offset:608
    v_mfma_f32_16x16x32_bf16 v[32:35], v[124:127], v[88:91], v[32:35]
    ds_read_b64_tr_b16 v[116:117], v220 offset:18688
    v_mfma_f32_16x16x32_bf16 v[36:39], v[128:131], v[88:91], v[36:39]
    ds_read_b64_tr_b16 v[118:119], v220 offset:20992
    v_mfma_f32_16x16x32_bf16 v[40:43], v[132:135], v[88:91], v[40:43]
    ds_read_b64_tr_b16 v[120:121], v221 offset:18976
    v_mfma_f32_16x16x32_bf16 v[44:47], v[136:139], v[88:91], v[44:47]
    ds_read_b128 v[88:91], v226 offset:608
    s_waitcnt lgkmcnt(9)
    v_mfma_f32_16x16x32_bf16 v[48:51], v[124:127], v[92:95], v[48:51]
    ds_read_b64_tr_b16 v[122:123], v221 offset:21280
    v_mfma_f32_16x16x32_bf16 v[52:55], v[128:131], v[92:95], v[52:55]
    v_mfma_f32_16x16x32_bf16 v[56:59], v[132:135], v[92:95], v[56:59]
    v_mfma_f32_16x16x32_bf16 v[60:63], v[136:139], v[92:95], v[60:63]
    ds_read_b128 v[92:95], v227 offset:608
    v_mfma_f32_16x16x32_bf16 v[0:3], v[100:103], v[80:83], v[0:3]
    s_add_u32 m0, s52, 131328
    s_add_u32 s54, s52, 331776
    buffer_load_dwordx4 v236, s[20:23], s54 offen offset:0  lds
    s_mov_b32 exec_hi, 0
    buffer_load_dwordx4 v236, s[20:23], s54 offen offset:1024  lds
    s_mov_b32 exec_hi, -1
L_m_U15:
    s_waitcnt vmcnt(6)
    s_barrier
    v_mfma_f32_16x16x32_bf16 v[4:7], v[104:107], v[80:83], v[4:7]
    ds_read_b64_tr_b16 v[124:125], v232 offset:36864
    s_waitcnt lgkmcnt(10)
    v_mfma_f32_16x16x32_bf16 v[8:11], v[108:111], v[80:83], v[8:11]
    ds_read_b64_tr_b16 v[126:127], v232 offset:39168
    s_waitcnt lgkmcnt(9)
    v_mfma_f32_16x16x32_bf16 v[12:15], v[112:115], v[80:83], v[12:15]
    ds_read_b64_tr_b16 v[128:129], v233 offset:36896
    s_waitcnt lgkmcnt(7)
    v_mfma_f32_16x16x32_bf16 v[64:67], v[116:119], v[80:83], v[64:67]
    ds_read_b64_tr_b16 v[130:131], v233 offset:39200
    s_waitcnt lgkmcnt(5)
    v_mfma_f32_16x16x32_bf16 v[72:75], v[120:123], v[80:83], v[72:75]
    ds_read_b128 v[80:83], v224 offset:672
    v_mfma_f32_16x16x32_bf16 v[68:71], v[116:119], v[96:99], v[68:71]
    ds_read_b64_tr_b16 v[132:133], v233 offset:37152
    v_mfma_f32_16x16x32_bf16 v[76:79], v[120:123], v[96:99], v[76:79]
    ds_read_b128 v[96:99], v224 offset:19104
    v_mfma_f32_16x16x32_bf16 v[16:19], v[100:103], v[84:87], v[16:19]
    ds_read_b64_tr_b16 v[134:135], v233 offset:39456
    v_mfma_f32_16x16x32_bf16 v[20:23], v[104:107], v[84:87], v[20:23]
    ds_read_b64_tr_b16 v[136:137], v232 offset:37184
    v_mfma_f32_16x16x32_bf16 v[24:27], v[108:111], v[84:87], v[24:27]
    ds_read_b64_tr_b16 v[138:139], v232 offset:39488
    v_mfma_f32_16x16x32_bf16 v[28:31], v[112:115], v[84:87], v[28:31]
    ds_read_b128 v[84:87], v225 offset:672
    v_mfma_f32_16x16x32_bf16 v[32:35], v[100:103], v[88:91], v[32:35]
    ds_read_b64_tr_b16 v[140:141], v220 offset:37120
    v_mfma_f32_16x16x32_bf16 v[36:39], v[104:107], v[88:91], v[36:39]
    ds_read_b64_tr_b16 v[142:143], v220 offset:39424
    v_mfma_f32_16x16x32_bf16 v[40:43], v[108:111], v[88:91], v[40:43]
    ds_read_b64_tr_b16 v[144:145], v221 offset:37408
    v_mfma_f32_16x16x32_bf16 v[44:47], v[112:115], v[88:91], v[44:47]
    ds_read_b128 v[88:91], v226 offset:672
    s_waitcnt lgkmcnt(9)
    v_mfma_f32_16x16x32_bf16 v[48:51], v[100:103], v[92:95], v[48:51]
    ds_read_b64_tr_b16 v[146:147], v221 offset:39712
    v_mfma_f32_16x16x32_bf16 v[52:55], v[104:107], v[92:95], v[52:55]
    v_mfma_f32_16x16x32_bf16 v[56:59], v[108:111], v[92:95], v[56:59]
    v_mfma_f32_16x16x32_bf16 v[60:63], v[112:115], v[92:95], v[60:63]
    ds_read_b128 v[92:95], v227 offset:672
    v_mfma_f32_16x16x32_bf16 v[0:3], v[124:127], v[80:83], v[0:3]
    s_add_u32 m0, s52, 39168
    s_add_u32 s54, s52, 350208
    buffer_load_dwordx4 v236, s[20:23], s54 offen offset:0  lds
    s_mov_b32 exec_hi, 0
    buffer_load_dwordx4 v236, s[20:23], s54 offen offset:1024  lds
    s_mov_b32 exec_hi, -1
L_m_U16:
    s_waitcnt vmcnt(6)
    s_barrier
    v_mfma_f32_16x16x32_bf16 v[4:7], v[128:131], v[80:83], v[4:7]
    ds_read_b64_tr_b16 v[100:101], v234 offset:0
    s_waitcnt lgkmcnt(10)
    v_mfma_f32_16x16x32_bf16 v[8:11], v[132:135], v[80:83], v[8:11]
    ds_read_b64_tr_b16 v[102:103], v234 offset:2304
    s_waitcnt lgkmcnt(9)
    v_mfma_f32_16x16x32_bf16 v[12:15], v[136:139], v[80:83], v[12:15]
    ds_read_b64_tr_b16 v[104:105], v235 offset:32
    s_waitcnt lgkmcnt(7)
    v_mfma_f32_16x16x32_bf16 v[64:67], v[140:143], v[80:83], v[64:67]
    ds_read_b64_tr_b16 v[106:107], v235 offset:2336
    s_waitcnt lgkmcnt(5)
    v_mfma_f32_16x16x32_bf16 v[72:75], v[144:147], v[80:83], v[72:75]
    ds_read_b128 v[80:83], v224 offset:736
    v_mfma_f32_16x16x32_bf16 v[68:71], v[140:143], v[96:99], v[68:71]
    ds_read_b64_tr_b16 v[108:109], v235 offset:288
    v_mfma_f32_16x16x32_bf16 v[76:79], v[144:147], v[96:99], v[76:79]
    ds_read_b128 v[96:99], v224 offset:19168
    v_mfma_f32_16x16x32_bf16 v[16:19], v[124:127], v[84:87], v[16:19]
    ds_read_b64_tr_b16 v[110:111], v235 offset:2592
    v_mfma_f32_16x16x32_bf16 v[20:23], v[128:131], v[84:87], v[20:23]
    ds_read_b64_tr_b16 v[112:113], v234 offset:320
    v_mfma_f32_16x16x32_bf16 v[24:27], v[132:135], v[84:87], v[24:27]
    ds_read_b64_tr_b16 v[114:115], v234 offset:2624
    v_mfma_f32_16x16x32_bf16 v[28:31], v[136:139], v[84:87], v[28:31]
    ds_read_b128 v[84:87], v225 offset:736
    v_mfma_f32_16x16x32_bf16 v[32:35], v[124:127], v[88:91], v[32:35]
    ds_read_b64_tr_b16 v[116:117], v222 offset:256
    v_mfma_f32_16x16x32_bf16 v[36:39], v[128:131], v[88:91], v[36:39]
    ds_read_b64_tr_b16 v[118:119], v222 offset:2560
    v_mfma_f32_16x16x32_bf16 v[40:43], v[132:135], v[88:91], v[40:43]
    ds_read_b64_tr_b16 v[120:121], v223 offset:544
    v_mfma_f32_16x16x32_bf16 v[44:47], v[136:139], v[88:91], v[44:47]
    ds_read_b128 v[88:91], v226 offset:736
    s_waitcnt lgkmcnt(9)
    v_mfma_f32_16x16x32_bf16 v[48:51], v[124:127], v[92:95], v[48:51]
    ds_read_b64_tr_b16 v[122:123], v223 offset:2848
    v_mfma_f32_16x16x32_bf16 v[52:55], v[128:131], v[92:95], v[52:55]
    v_mfma_f32_16x16x32_bf16 v[56:59], v[132:135], v[92:95], v[56:59]
    v_mfma_f32_16x16x32_bf16 v[60:63], v[136:139], v[92:95], v[60:63]
    ds_read_b128 v[92:95], v227 offset:736
    v_mfma_f32_16x16x32_bf16 v[0:3], v[100:103], v[80:83], v[0:3]
    s_add_u32 m0, s52, 57600
    s_add_u32 s54, s52, 368640
    buffer_load_dwordx4 v236, s[20:23], s54 offen offset:0  lds
    s_mov_b32 exec_hi, 0
    buffer_load_dwordx4 v236, s[20:23], s54 offen offset:1024  lds
    s_mov_b32 exec_hi, -1
L_m_U17:
    s_waitcnt vmcnt(6)
    s_barrier
    v_mfma_f32_16x16x32_bf16 v[4:7], v[104:107], v[80:83], v[4:7]
    ds_read_b64_tr_b16 v[124:125], v234 offset:18432
    s_waitcnt lgkmcnt(10)
    v_mfma_f32_16x16x32_bf16 v[8:11], v[108:111], v[80:83], v[8:11]
    ds_read_b64_tr_b16 v[126:127], v234 offset:20736
    s_waitcnt lgkmcnt(9)
    v_mfma_f32_16x16x32_bf16 v[12:15], v[112:115], v[80:83], v[12:15]
    ds_read_b64_tr_b16 v[128:129], v235 offset:18464
    s_waitcnt lgkmcnt(7)
    v_mfma_f32_16x16x32_bf16 v[64:67], v[116:119], v[80:83], v[64:67]
    ds_read_b64_tr_b16 v[130:131], v235 offset:20768
    s_waitcnt lgkmcnt(5)
    v_mfma_f32_16x16x32_bf16 v[72:75], v[120:123], v[80:83], v[72:75]
    ds_read_b128 v[80:83], v224 offset:800
    v_mfma_f32_16x16x32_bf16 v[68:71], v[116:119], v[96:99], v[68:71]
    ds_read_b64_tr_b16 v[132:133], v235 offset:18720
    v_mfma_f32_16x16x32_bf16 v[76:79], v[120:123], v[96:99], v[76:79]
    ds_read_b128 v[96:99], v224 offset:19232
    v_mfma_f32_16x16x32_bf16 v[16:19], v[100:103], v[84:87], v[16:19]
    ds_read_b64_tr_b16 v[134:135], v235 offset:21024
    v_mfma_f32_16x16x32_bf16 v[20:23], v[104:107], v[84:87], v[20:23]
    ds_read_b64_tr_b16 v[136:137], v234 offset:18752
    v_mfma_f32_16x16x32_bf16 v[24:27], v[108:111], v[84:87], v[24:27]
    ds_read_b64_tr_b16 v[138:139], v234 offset:21056
    v_mfma_f32_16x16x32_bf16 v[28:31], v[112:115], v[84:87], v[28:31]
    ds_read_b128 v[84:87], v225 offset:800
    v_mfma_f32_16x16x32_bf16 v[32:35], v[100:103], v[88:91], v[32:35]
    ds_read_b64_tr_b16 v[140:141], v222 offset:18688
    v_mfma_f32_16x16x32_bf16 v[36:39], v[104:107], v[88:91], v[36:39]
    ds_read_b64_tr_b16 v[142:143], v222 offset:20992
    v_mfma_f32_16x16x32_bf16 v[40:43], v[108:111], v[88:91], v[40:43]
    ds_read_b64_tr_b16 v[144:145], v223 offset:18976
    v_mfma_f32_16x16x32_bf16 v[44:47], v[112:115], v[88:91], v[44:47]
    ds_read_b128 v[88:91], v226 offset:800
    s_waitcnt lgkmcnt(9)
    v_mfma_f32_16x16x32_bf16 v[48:51], v[100:103], v[92:95], v[48:51]
    ds_read_b64_tr_b16 v[146:147], v223 offset:21280
    v_mfma_f32_16x16x32_bf16 v[52:55], v[104:107], v[92:95], v[52:55]
    v_mfma_f32_16x16x32_bf16 v[56:59], v[108:111], v[92:95], v[56:59]
    v_mfma_f32_16x16x32_bf16 v[60:63], v[112:115], v[92:95], v[60:63]
    ds_read_b128 v[92:95], v227 offset:800
    v_mfma_f32_16x16x32_bf16 v[0:3], v[124:127], v[80:83], v[0:3]
    s_add_u32 m0, s52, 76032
    s_add_u32 s54, s52, 387072
    buffer_load_dwordx4 v236, s[20:23], s54 offen offset:0  lds
    s_mov_b32 exec_hi, 0
    buffer_load_dwordx4 v236, s[20:23], s54 offen offset:1024  lds
    s_mov_b32 exec_hi, -1
L_m_U18:
    s_waitcnt vmcnt(6)
    s_barrier
    v_mfma_f32_16x16x32_bf16 v[4:7], v[128:131], v[80:83], v[4:7]
    ds_read_b64_tr_b16 v[100:101], v234 offset:36864
    s_waitcnt lgkmcnt(10)
    v_mfma_f32_16x16x32_bf16 v[8:11], v[132:135], v[80:83], v[8:11]
    ds_read_b64_tr_b16 v[102:103], v234 offset:39168
    s_waitcnt lgkmcnt(9)
    v_mfma_f32_16x16x32_bf16 v[12:15], v[136:139], v[80:83], v[12:15]
    ds_read_b64_tr_b16 v[104:105], v235 offset:36896
    s_waitcnt lgkmcnt(7)
    v_mfma_f32_16x16x32_bf16 v[64:67], v[140:143], v[80:83], v[64:67]
    ds_read_b64_tr_b16 v[106:107], v235 offset:39200
    s_waitcnt lgkmcnt(5)
    v_mfma_f32_16x16x32_bf16 v[72:75], v[144:147], v[80:83], v[72:75]
    ds_read_b128 v[80:83], v224 offset:0
    v_mfma_f32_16x16x32_bf16 v[68:71], v[140:143], v[96:99], v[68:71]
    ds_read_b64_tr_b16 v[108:109], v235 offset:37152
    v_mfma_f32_16x16x32_bf16 v[76:79], v[144:147], v[96:99], v[76:79]
    ds_read_b128 v[96:99], v224 offset:18432
    v_mfma_f32_16x16x32_bf16 v[16:19], v[124:127], v[84:87], v[16:19]
    ds_read_b64_tr_b16 v[110:111], v235 offset:39456
    v_mfma_f32_16x16x32_bf16 v[20:23], v[128:131], v[84:87], v[20:23]
    ds_read_b64_tr_b16 v[112:113], v234 offset:37184
    v_mfma_f32_16x16x32_bf16 v[24:27], v[132:135], v[84:87], v[24:27]
    ds_read_b64_tr_b16 v[114:115], v234 offset:39488
    v_mfma_f32_16x16x32_bf16 v[28:31], v[136:139], v[84:87], v[28:31]
    ds_read_b128 v[84:87], v225 offset:0
    v_mfma_f32_16x16x32_bf16 v[32:35], v[124:127], v[88:91], v[32:35]
    ds_read_b64_tr_b16 v[116:117], v222 offset:37120
    v_mfma_f32_16x16x32_bf16 v[36:39], v[128:131], v[88:91], v[36:39]
    ds_read_b64_tr_b16 v[118:119], v222 offset:39424
    v_mfma_f32_16x16x32_bf16 v[40:43], v[132:135], v[88:91], v[40:43]
    ds_read_b64_tr_b16 v[120:121], v223 offset:37408
    v_mfma_f32_16x16x32_bf16 v[44:47], v[136:139], v[88:91], v[44:47]
    ds_read_b128 v[88:91], v226 offset:0
    s_waitcnt lgkmcnt(9)
    v_mfma_f32_16x16x32_bf16 v[48:51], v[124:127], v[92:95], v[48:51]
    ds_read_b64_tr_b16 v[122:123], v223 offset:39712
    v_mfma_f32_16x16x32_bf16 v[52:55], v[128:131], v[92:95], v[52:55]
    v_mfma_f32_16x16x32_bf16 v[56:59], v[132:135], v[92:95], v[56:59]
    v_mfma_f32_16x16x32_bf16 v[60:63], v[136:139], v[92:95], v[60:63]
    ds_read_b128 v[92:95], v227 offset:0
    v_mfma_f32_16x16x32_bf16 v[0:3], v[100:103], v[80:83], v[0:3]
L_m_U19:
    s_waitcnt vmcnt(4)
    s_barrier
    v_mfma_f32_16x16x32_bf16 v[4:7], v[104:107], v[80:83], v[4:7]
    ds_read_b64_tr_b16 v[124:125], v232 offset:0
    s_waitcnt lgkmcnt(10)
    v_mfma_f32_16x16x32_bf16 v[8:11], v[108:111], v[80:83], v[8:11]
    ds_read_b64_tr_b16 v[126:127], v232 offset:2304
    s_waitcnt lgkmcnt(9)
    v_mfma_f32_16x16x32_bf16 v[12:15], v[112:115], v[80:83], v[12:15]
    ds_read_b64_tr_b16 v[128:129], v233 offset:32
    s_waitcnt lgkmcnt(7)
    v_mfma_f32_16x16x32_bf16 v[64:67], v[116:119], v[80:83], v[64:67]
    ds_read_b64_tr_b16 v[130:131], v233 offset:2336
    s_waitcnt lgkmcnt(5)
    v_mfma_f32_16x16x32_bf16 v[72:75], v[120:123], v[80:83], v[72:75]
    ds_read_b128 v[80:83], v224 offset:64
    v_mfma_f32_16x16x32_bf16 v[68:71], v[116:119], v[96:99], v[68:71]
    ds_read_b64_tr_b16 v[132:133], v233 offset:288
    v_mfma_f32_16x16x32_bf16 v[76:79], v[120:123], v[96:99], v[76:79]
    ds_read_b128 v[96:99], v224 offset:18496
    v_mfma_f32_16x16x32_bf16 v[16:19], v[100:103], v[84:87], v[16:19]
    ds_read_b64_tr_b16 v[134:135], v233 offset:2592
    v_mfma_f32_16x16x32_bf16 v[20:23], v[104:107], v[84:87], v[20:23]
    ds_read_b64_tr_b16 v[136:137], v232 offset:320
    v_mfma_f32_16x16x32_bf16 v[24:27], v[108:111], v[84:87], v[24:27]
    ds_read_b64_tr_b16 v[138:139], v232 offset:2624
    v_mfma_f32_16x16x32_bf16 v[28:31], v[112:115], v[84:87], v[28:31]
    ds_read_b128 v[84:87], v225 offset:64
    v_mfma_f32_16x16x32_bf16 v[32:35], v[100:103], v[88:91], v[32:35]
    ds_read_b64_tr_b16 v[140:141], v220 offset:256
    v_mfma_f32_16x16x32_bf16 v[36:39], v[104:107], v[88:91], v[36:39]
    ds_read_b64_tr_b16 v[142:143], v220 offset:2560
    v_mfma_f32_16x16x32_bf16 v[40:43], v[108:111], v[88:91], v[40:43]
    ds_read_b64_tr_b16 v[144:145], v221 offset:544
    v_mfma_f32_16x16x32_bf16 v[44:47], v[112:115], v[88:91], v[44:47]
    ds_read_b128 v[88:91], v226 offset:64
    s_waitcnt lgkmcnt(9)
    v_mfma_f32_16x16x32_bf16 v[48:51], v[100:103], v[92:95], v[48:51]
    ds_read_b64_tr_b16 v[146:147], v221 offset:2848
    v_mfma_f32_16x16x32_bf16 v[52:55], v[104:107], v[92:95], v[52:55]
    v_mfma_f32_16x16x32_bf16 v[56:59], v[108:111], v[92:95], v[56:59]
    v_mfma_f32_16x16x32_bf16 v[60:63], v[112:115], v[92:95], v[60:63]
    ds_read_b128 v[92:95], v227 offset:64
    v_mfma_f32_16x16x32_bf16 v[0:3], v[124:127], v[80:83], v[0:3]
L_m_U20:
    s_waitcnt vmcnt(0)
    s_barrier
    v_mfma_f32_16x16x32_bf16 v[4:7], v[128:131], v[80:83], v[4:7]
    ds_read_b64_tr_b16 v[100:101], v232 offset:18432
    s_waitcnt lgkmcnt(10)
    v_mfma_f32_16x16x32_bf16 v[8:11], v[132:135], v[80:83], v[8:11]
    ds_read_b64_tr_b16 v[102:103], v232 offset:20736
    s_waitcnt lgkmcnt(9)
    v_mfma_f32_16x16x32_bf16 v[12:15], v[136:139], v[80:83], v[12:15]
    ds_read_b64_tr_b16 v[104:105], v233 offset:18464
    s_waitcnt lgkmcnt(7)
    v_mfma_f32_16x16x32_bf16 v[64:67], v[140:143], v[80:83], v[64:67]
    ds_read_b64_tr_b16 v[106:107], v233 offset:20768
    s_waitcnt lgkmcnt(5)
    v_mfma_f32_16x16x32_bf16 v[72:75], v[144:147], v[80:83], v[72:75]
    ds_read_b128 v[80:83], v224 offset:128
    v_mfma_f32_16x16x32_bf16 v[68:71], v[140:143], v[96:99], v[68:71]
    ds_read_b64_tr_b16 v[108:109], v233 offset:18720
    v_mfma_f32_16x16x32_bf16 v[76:79], v[144:147], v[96:99], v[76:79]
    ds_read_b128 v[96:99], v224 offset:18560
    v_mfma_f32_16x16x32_bf16 v[16:19], v[124:127], v[84:87], v[16:19]
    ds_read_b64_tr_b16 v[110:111], v233 offset:21024
    v_mfma_f32_16x16x32_bf16 v[20:23], v[128:131], v[84:87], v[20:23]
    ds_read_b64_tr_b16 v[112:113], v232 offset:18752
    v_mfma_f32_16x16x32_bf16 v[24:27], v[132:135], v[84:87], v[24:27]
    ds_read_b64_tr_b16 v[114:115], v232 offset:21056
    v_mfma_f32_16x16x32_bf16 v[28:31], v[136:139], v[84:87], v[28:31]
    ds_read_b128 v[84:87], v225 offset:128
    v_mfma_f32_16x16x32_bf16 v[32:35], v[124:127], v[88:91], v[32:35]
    ds_read_b64_tr_b16 v[116:117], v220 offset:18688
    v_mfma_f32_16x16x32_bf16 v[36:39], v[128:131], v[88:91], v[36:39]
L_wp1:
    s_cbranch_execz L_wback
    ds_read_b64_tr_b16 v[118:119], v220 offset:20992
    v_mfma_f32_16x16x32_bf16 v[40:43], v[132:135], v[88:91], v[40:43]
    ds_read_b64_tr_b16 v[120:121], v221 offset:18976
    v_mfma_f32_16x16x32_bf16 v[44:47], v[136:139], v[88:91], v[44:47]
    ds_read_b128 v[88:91], v226 offset:128
    s_waitcnt lgkmcnt(9)
    v_mfma_f32_16x16x32_bf16 v[48:51], v[124:127], v[92:95], v[48:51]
    ds_read_b64_tr_b16 v[122:123], v221 offset:21280
    v_mfma_f32_16x16x32_bf16 v[52:55], v[128:131], v[92:95], v[52:55]
    v_mfma_f32_16x16x32_bf16 v[56:59], v[132:135], v[92:95], v[56:59]
    v_mfma_f32_16x16x32_bf16 v[60:63], v[136:139], v[92:95], v[60:63]
    ds_read_b128 v[92:95], v227 offset:128
    v_mfma_f32_16x16x32_bf16 v[0:3], v[100:103], v[80:83], v[0:3]
    ds_read_b64_tr_b16 v[124:125], v232 offset:36864
    v_mfma_f32_16x16x32_bf16 v[4:7], v[104:107], v[80:83], v[4:7]
    ds_read_b64_tr_b16 v[126:127], v232 offset:39168
    s_waitcnt lgkmcnt(11)
    v_mfma_f32_16x16x32_bf16 v[8:11], v[108:111], v[80:83], v[8:11]
    ds_read_b64_tr_b16 v[128:129], v233 offset:36896
    s_waitcnt lgkmcnt(10)
    v_mfma_f32_16x16x32_bf16 v[12:15], v[112:115], v[80:83], v[12:15]
    ds_read_b64_tr_b16 v[130:131], v233 offset:39200
    s_waitcnt lgkmcnt(8)
    v_mfma_f32_16x16x32_bf16 v[64:67], v[116:119], v[80:83], v[64:67]
    ds_read_b64_tr_b16 v[132:133], v233 offset:37152
    s_waitcnt lgkmcnt(6)
    v_mfma_f32_16x16x32_bf16 v[72:75], v[120:123], v[80:83], v[72:75]
    ds_read_b128 v[80:83], v224 offset:192
    v_mfma_f32_16x16x32_bf16 v[68:71], v[116:119], v[96:99], v[68:71]
    ds_read_b64_tr_b16 v[134:135], v233 offset:39456
    v_mfma_f32_16x16x32_bf16 v[76:79], v[120:123], v[96:99], v[76:79]
    ds_read_b128 v[96:99], v224 offset:18624
    v_mfma_f32_16x16x32_bf16 v[16:19], v[100:103], v[84:87], v[16:19]
    ds_read_b64_tr_b16 v[136:137], v232 offset:37184
    v_mfma_f32_16x16x32_bf16 v[20:23], v[104:107], v[84:87], v[20:23]
    ds_read_b64_tr_b16 v[138:139], v232 offset:39488
    v_mfma_f32_16x16x32_bf16 v[24:27], v[108:111], v[84:87], v[24:27]
    ds_read_b64_tr_b16 v[140:141], v220 offset:37120
    v_mfma_f32_16x16x32_bf16 v[28:31], v[112:115], v[84:87], v[28:31]
    ds_read_b128 v[84:87], v225 offset:192
    v_mfma_f32_16x16x32_bf16 v[32:35], v[100:103], v[88:91], v[32:35]
    ds_read_b64_tr_b16 v[142:143], v220 offset:39424
    v_mfma_f32_16x16x32_bf16 v[36:39], v[104:107], v[88:91], v[36:39]
    ds_read_b64_tr_b16 v[144:145], v221 offset:37408
    v_mfma_f32_16x16x32_bf16 v[40:43], v[108:111], v[88:91], v[40:43]
    ds_read_b64_tr_b16 v[146:147], v221 offset:39712
    v_mfma_f32_16x16x32_bf16 v[44:47], v[112:115], v[88:91], v[44:47]
    ds_read_b128 v[88:91], v226 offset:192
    s_waitcnt lgkmcnt(9)
    v_mfma_f32_16x16x32_bf16 v[48:51], v[100:103], v[92:95], v[48:51]
    v_mfma_f32_16x16x32_bf16 v[52:55], v[104:107], v[92:95], v[52:55]
    v_mfma_f32_16x16x32_bf16 v[56:59], v[108:111], v[92:95], v[56:59]
    v_mfma_f32_16x16x32_bf16 v[60:63], v[112:115], v[92:95], v[60:63]
    ds_read_b128 v[92:95], v227 offset:192
    v_mfma_f32_16x16x32_bf16 v[0:3], v[124:127], v[80:83], v[0:3]
    ds_read_b64_tr_b16 v[100:101], v234 offset:0
    v_mfma_f32_16x16x32_bf16 v[4:7], v[128:131], v[80:83], v[4:7]
    ds_read_b64_tr_b16 v[102:103], v234 offset:2304
    v_mfma_f32_16x16x32_bf16 v[8:11], v[132:135], v[80:83], v[8:11]
    ds_read_b64_tr_b16 v[104:105], v235 offset:32
    s_waitcnt lgkmcnt(10)
    v_mfma_f32_16x16x32_bf16 v[12:15], v[136:139], v[80:83], v[12:15]
    ds_read_b64_tr_b16 v[106:107], v235 offset:2336
    s_waitcnt lgkmcnt(8)
    v_mfma_f32_16x16x32_bf16 v[64:67], v[140:143], v[80:83], v[64:67]
    ds_read_b64_tr_b16 v[108:109], v235 offset:288
    s_waitcnt lgkmcnt(7)
    v_mfma_f32_16x16x32_bf16 v[72:75], v[144:147], v[80:83], v[72:75]
    ds_read_b128 v[80:83], v224 offset:256
    v_mfma_f32_16x16x32_bf16 v[68:71], v[140:143], v[96:99], v[68:71]
    ds_read_b64_tr_b16 v[110:111], v235 offset:2592
    v_mfma_f32_16x16x32_bf16 v[76:79], v[144:147], v[96:99], v[76:79]
    ds_read_b128 v[96:99], v224 offset:18688
    v_mfma_f32_16x16x32_bf16 v[16:19], v[124:127], v[84:87], v[16:19]
    ds_read_b64_tr_b16 v[112:113], v234 offset:320
    v_mfma_f32_16x16x32_bf16 v[20:23], v[128:131], v[84:87], v[20:23]
    ds_read_b64_tr_b16 v[114:115], v234 offset:2624
    v_mfma_f32_16x16x32_bf16 v[24:27], v[132:135], v[84:87], v[24:27]
    ds_read_b64_tr_b16 v[116:117], v222 offset:256
    v_mfma_f32_16x16x32_bf16 v[28:31], v[136:139], v[84:87], v[28:31]
    ds_read_b128 v[84:87], v225 offset:256
    s_waitcnt lgkmcnt(9)
    v_mfma_f32_16x16x32_bf16 v[32:35], v[124:127], v[88:91], v[32:35]
    ds_read_b64_tr_b16 v[118:119], v222 offset:2560
    v_mfma_f32_16x16x32_bf16 v[36:39], v[128:131], v[88:91], v[36:39]
    ds_read_b64_tr_b16 v[120:121], v223 offset:544
    v_mfma_f32_16x16x32_bf16 v[40:43], v[132:135], v[88:91], v[40:43]
    ds_read_b64_tr_b16 v[122:123], v223 offset:2848
    v_mfma_f32_16x16x32_bf16 v[44:47], v[136:139], v[88:91], v[44:47]
    ds_read_b128 v[88:91], v226 offset:256
    v_mfma_f32_16x16x32_bf16 v[48:51], v[124:127], v[92:95], v[48:51]
    v_mfma_f32_16x16x32_bf16 v[52:55], v[128:131], v[92:95], v[52:55]
    v_mfma_f32_16x16x32_bf16 v[56:59], v[132:135], v[92:95], v[56:59]
    v_mfma_f32_16x16x32_bf16 v[60:63], v[136:139], v[92:95], v[60:63]
    ds_read_b128 v[92:95], v227 offset:256
    s_waitcnt lgkmcnt(11)
    v_mfma_f32_16x16x32_bf16 v[0:3], v[100:103], v[80:83], v[0:3]
    v_mfma_f32_16x16x32_bf16 v[4:7], v[104:107], v[80:83], v[4:7]
    s_waitcnt lgkmcnt(10)
    v_mfma_f32_16x16x32_bf16 v[8:11], v[108:111], v[80:83], v[8:11]
    s_waitcnt lgkmcnt(7)
    v_mfma_f32_16x16x32_bf16 v[12:15], v[112:115], v[80:83], v[12:15]
    s_waitcnt lgkmcnt(4)
    v_mfma_f32_16x16x32_bf16 v[64:67], v[116:119], v[80:83], v[64:67]
    s_waitcnt lgkmcnt(2)
    v_mfma_f32_16x16x32_bf16 v[72:75], v[120:123], v[80:83], v[72:75]
    v_mfma_f32_16x16x32_bf16 v[68:71], v[116:119], v[96:99], v[68:71]
    v_mfma_f32_16x16x32_bf16 v[76:79], v[120:123], v[96:99], v[76:79]
    v_mfma_f32_16x16x32_bf16 v[16:19], v[100:103], v[84:87], v[16:19]
    v_mfma_f32_16x16x32_bf16 v[20:23], v[104:107], v[84:87], v[20:23]
    v_mfma_f32_16x16x32_bf16 v[24:27], v[108:111], v[84:87], v[24:27]
    v_mfma_f32_16x16x32_bf16 v[28:31], v[112:115], v[84:87], v[28:31]
    s_waitcnt lgkmcnt(1)
    v_mfma_f32_16x16x32_bf16 v[32:35], v[100:103], v[88:91], v[32:35]
    v_mfma_f32_16x16x32_bf16 v[36:39], v[104:107], v[88:91], v[36:39]
    v_mfma_f32_16x16x32_bf16 v[40:43], v[108:111], v[88:91], v[40:43]
    v_mfma_f32_16x16x32_bf16 v[44:47], v[112:115], v[88:91], v[44:47]
    s_waitcnt lgkmcnt(0)
    v_mfma_f32_16x16x32_bf16 v[48:51], v[100:103], v[92:95], v[48:51]
    v_mfma_f32_16x16x32_bf16 v[52:55], v[104:107], v[92:95], v[52:55]
    v_mfma_f32_16x16x32_bf16 v[56:59], v[108:111], v[92:95], v[56:59]
    v_mfma_f32_16x16x32_bf16 v[60:63], v[112:115], v[92:95], v[60:63]
    s_barrier
    v_lshl_add_u32 v224, v240, 3, s58
    v_add_u32 v249, s12, v241
    v_add_u32 v238, s13, v241
    v_add_u32 v239, s14, v241
    v_add_u32 v236, s15, v241
    s_nop 1
    v_max3_f32 v160, |v0|, |v1|, |v2|
    v_max3_f32 v161, |v3|, |v4|, |v5|
    v_max3_f32 v160, v160, |v6|, |v7|
    v_max3_f32 v161, v161, |v64|, |v65|
    v_max3_f32 v160, v160, |v66|, |v67|
    v_max3_f32 v161, v161, |v68|, |v69|
    v_max3_f32 v160, v160, |v70|, |v71|
    v_max3_f32 v161, v161, |v16|, |v17|
    v_max3_f32 v160, v160, |v18|, |v19|
    v_max3_f32 v161, v161, |v20|, |v21|
    v_max3_f32 v160, v160, |v22|, |v23|
    v_max3_f32 v161, v161, |v32|, |v33|
    v_max3_f32 v160, v160, |v34|, |v35|
    v_max3_f32 v161, v161, |v36|, |v37|
    v_max3_f32 v160, v160, |v38|, |v39|
    v_max3_f32 v161, v161, |v48|, |v49|
    v_max3_f32 v160, v160, |v50|, |v51|
    v_max3_f32 v161, v161, |v52|, |v53|
    v_max3_f32 v160, v160, |v54|, |v55|
    v_max_f32 v160, v160, v161
    v_cmp_lt_f32 vcc, s44, v160
    s_cbranch_vccnz L_clampU
L_clampedU:
    v_mul_f32 v64, s40, v64
    v_mul_f32 v72, s42, v72
    v_mul_f32 v65, s40, v65
    v_mul_f32 v73, s42, v73
    v_mul_f32 v66, s40, v66
    v_mul_f32 v74, s42, v74
    v_mul_f32 v67, s40, v67
    v_mul_f32 v75, s42, v75
    v_mul_f32 v68, s40, v68
    v_mul_f32 v76, s42, v76
    v_mul_f32 v69, s40, v69
    v_mul_f32 v77, s42, v77
    v_mul_f32 v70, s40, v70
    v_mul_f32 v78, s42, v78
    v_mul_f32 v71, s40, v71
    v_mul_f32 v79, s42, v79
    v_exp_f32 v72, v72
    v_exp_f32 v73, v73
    v_exp_f32 v74, v74
    v_exp_f32 v75, v75
    v_exp_f32 v76, v76
    v_exp_f32 v77, v77
    v_exp_f32 v78, v78
    v_exp_f32 v79, v79
    v_exp_f32 v64, v64
    v_exp_f32 v65, v65
    v_exp_f32 v66, v66
    v_exp_f32 v67, v67
    v_exp_f32 v68, v68
    v_exp_f32 v69, v69
    v_exp_f32 v70, v70
    v_exp_f32 v71, v71
    v_add_f32 v72, 1.0, v72
    v_add_f32 v73, 1.0, v73
    v_add_f32 v74, 1.0, v74
    v_add_f32 v75, 1.0, v75
    v_add_f32 v76, 1.0, v76
    v_add_f32 v77, 1.0, v77
    v_add_f32 v78, 1.0, v78
    v_add_f32 v79, 1.0, v79
    v_fma_f32 v72, v64, v72, v72
    v_fma_f32 v73, v65, v73, v73
    v_fma_f32 v74, v66, v74, v74
    v_fma_f32 v75, v67, v75, v75
    v_fma_f32 v76, v68, v76, v76
    v_fma_f32 v77, v69, v77, v77
    v_fma_f32 v78, v70, v78, v78
    v_fma_f32 v79, v71, v79, v79
    v_rcp_f32 v72, v72
    v_rcp_f32 v73, v73
    v_rcp_f32 v74, v74
    v_rcp_f32 v75, v75
    v_rcp_f32 v76, v76
    v_rcp_f32 v77, v77
    v_rcp_f32 v78, v78
    v_rcp_f32 v79, v79
    v_fma_f32 v64, v64, v72, -v72
    v_fma_f32 v65, v65, v73, -v73
    v_fma_f32 v66, v66, v74, -v74
    v_fma_f32 v67, v67, v75, -v75
    v_fma_f32 v68, v68, v76, -v76
    v_fma_f32 v69, v69, v77, -v77
    v_fma_f32 v70, v70, v78, -v78
    v_fma_f32 v71, v71, v79, -v79
    v_cvt_pk_bf16_f32 v96, v64, v65
    v_cvt_pk_bf16_f32 v97, v66, v67
    v_cvt_pk_bf16_f32 v98, v68, v69
    v_cvt_pk_bf16_f32 v99, v70, v71
    ds_write_b64 v224, v[98:99]
    v_mul_f32 v16, s40, v16
    v_mul_f32 v24, s42, v24
    v_mul_f32 v17, s40, v17
    v_mul_f32 v25, s42, v25
    v_mul_f32 v18, s40, v18
    v_mul_f32 v26, s42, v26
    v_mul_f32 v19, s40, v19
    v_mul_f32 v27, s42, v27
    v_mul_f32 v20, s40, v20
    v_mul_f32 v28, s42, v28
    v_mul_f32 v21, s40, v21
    v_mul_f32 v29, s42, v29
    v_mul_f32 v22, s40, v22
    v_mul_f32 v30, s42, v30
    v_mul_f32 v23, s40, v23
    v_mul_f32 v31, s42, v31
    v_exp_f32 v24, v24
    v_exp_f32 v25, v25
    v_exp_f32 v26, v26
    v_exp_f32 v27, v27
    v_exp_f32 v28, v28
    v_exp_f32 v29, v29
    v_exp_f32 v30, v30
    v_exp_f32 v31, v31
    v_exp_f32 v16, v16
    v_exp_f32 v17, v17
    v_exp_f32 v18, v18
    v_exp_f32 v19, v19
    v_exp_f32 v20, v20
    v_exp_f32 v21, v21
    v_exp_f32 v22, v22
    v_exp_f32 v23, v23
    v_add_f32 v24, 1.0, v24
    v_add_f32 v25, 1.0, v25
    v_add_f32 v26, 1.0, v26
    v_add_f32 v27, 1.0, v27
    v_add_f32 v28, 1.0, v28
    v_add_f32 v29, 1.0, v29
    v_add_f32 v30, 1.0, v30
    v_add_f32 v31, 1.0, v31
    v_fma_f32 v24, v16, v24, v24
    v_fma_f32 v25, v17, v25, v25
    v_fma_f32 v26, v18, v26, v26
    v_fma_f32 v27, v19, v27, v27
    v_fma_f32 v28, v20, v28, v28
    v_fma_f32 v29, v21, v29, v29
    v_fma_f32 v30, v22, v30, v30
    v_fma_f32 v31, v23, v31, v31
    v_rcp_f32 v24, v24
    v_rcp_f32 v25, v25
    v_rcp_f32 v26, v26
    v_rcp_f32 v27, v27
    v_rcp_f32 v28, v28
    v_rcp_f32 v29, v29
    v_rcp_f32 v30, v30
    v_rcp_f32 v31, v31
    v_fma_f32 v16, v16, v24, -v24
    v_fma_f32 v17, v17, v25, -v25
    v_fma_f32 v18, v18, v26, -v26
    v_fma_f32 v19, v19, v27, -v27
    v_fma_f32 v20, v20, v28, -v28
    v_fma_f32 v21, v21, v29, -v29
    v_fma_f32 v22, v22, v30, -v30
    v_fma_f32 v23, v23, v31, -v31
    v_cvt_pk_bf16_f32 v84, v16, v17
    v_cvt_pk_bf16_f32 v85, v18, v19
    v_cvt_pk_bf16_f32 v86, v20, v21
    v_cvt_pk_bf16_f32 v87, v22, v23
    ds_write_b128 v250, v[84:87] offset:3072
    v_mul_f32 v32, s40, v32
    v_mul_f32 v40, s42, v40
    v_mul_f32 v33, s40, v33
    v_mul_f32 v41, s42, v41
    v_mul_f32 v34, s40, v34
    v_mul_f32 v42, s42, v42
    v_mul_f32 v35, s40, v35
    v_mul_f32 v43, s42, v43
    v_mul_f32 v36, s40, v36
    v_mul_f32 v44, s42, v44
    v_mul_f32 v37, s40, v37
    v_mul_f32 v45, s42, v45
    v_mul_f32 v38, s40, v38
    v_mul_f32 v46, s42, v46
    v_mul_f32 v39, s40, v39
    v_mul_f32 v47, s42, v47
    v_exp_f32 v40, v40
    v_exp_f32 v41, v41
    v_exp_f32 v42, v42
    v_exp_f32 v43, v43
    v_exp_f32 v44, v44
    v_exp_f32 v45, v45
    v_exp_f32 v46, v46
    v_exp_f32 v47, v47
    v_exp_f32 v32, v32
    v_exp_f32 v33, v33
    v_exp_f32 v34, v34
    v_exp_f32 v35, v35
    v_exp_f32 v36, v36
    v_exp_f32 v37, v37
    v_exp_f32 v38, v38
    v_exp_f32 v39, v39
    v_add_f32 v40, 1.0, v40
    v_add_f32 v41, 1.0, v41
    v_add_f32 v42, 1.0, v42
    v_add_f32 v43, 1.0, v43
    v_add_f32 v44, 1.0, v44
    v_add_f32 v45, 1.0, v45
    v_add_f32 v46, 1.0, v46
    v_add_f32 v47, 1.0, v47
    v_fma_f32 v40, v32, v40, v40
    v_fma_f32 v41, v33, v41, v41
    v_fma_f32 v42, v34, v42, v42
    v_fma_f32 v43, v35, v43, v43
    v_fma_f32 v44, v36, v44, v44
    v_fma_f32 v45, v37, v45, v45
    v_fma_f32 v46, v38, v46, v46
    v_fma_f32 v47, v39, v47, v47
    v_rcp_f32 v40, v40
    v_rcp_f32 v41, v41
    v_rcp_f32 v42, v42
    v_rcp_f32 v43, v43
    v_rcp_f32 v44, v44
    v_rcp_f32 v45, v45
    v_rcp_f32 v46, v46
    v_rcp_f32 v47, v47
    v_fma_f32 v32, v32, v40, -v40
    v_fma_f32 v33, v33, v41, -v41
    v_fma_f32 v34, v34, v42, -v42
    v_fma_f32 v35, v35, v43, -v43
    v_fma_f32 v36, v36, v44, -v44
    v_fma_f32 v37, v37, v45, -v45
    v_fma_f32 v38, v38, v46, -v46
    v_fma_f32 v39, v39, v47, -v47
    v_cvt_pk_bf16_f32 v88, v32, v33
    v_cvt_pk_bf16_f32 v89, v34, v35
    v_cvt_pk_bf16_f32 v90, v36, v37
    v_cvt_pk_bf16_f32 v91, v38, v39
    ds_write_b128 v251, v[88:91] offset:2048
    v_mul_f32 v48, s40, v48
    v_mul_f32 v56, s42, v56
    v_mul_f32 v49, s40, v49
    v_mul_f32 v57, s42, v57
    v_mul_f32 v50, s40, v50
    v_mul_f32 v58, s42, v58
    v_mul_f32 v51, s40, v51
    v_mul_f32 v59, s42, v59
    v_mul_f32 v52, s40, v52
    v_mul_f32 v60, s42, v60
    v_mul_f32 v53, s40, v53
    v_mul_f32 v61, s42, v61
    v_mul_f32 v54, s40, v54
    v_mul_f32 v62, s42, v62
    v_mul_f32 v55, s40, v55
    v_mul_f32 v63, s42, v63
    v_exp_f32 v56, v56
    v_exp_f32 v57, v57
    v_exp_f32 v58, v58
    v_exp_f32 v59, v59
    v_exp_f32 v60, v60
    v_exp_f32 v61, v61
    v_exp_f32 v62, v62
    v_exp_f32 v63, v63
    v_exp_f32 v48, v48
    v_exp_f32 v49, v49
    v_exp_f32 v50, v50
    v_exp_f32 v51, v51
    v_exp_f32 v52, v52
    v_exp_f32 v53, v53
    v_exp_f32 v54, v54
    v_exp_f32 v55, v55
    v_add_f32 v56, 1.0, v56
    v_add_f32 v57, 1.0, v57
    v_add_f32 v58, 1.0, v58
    v_add_f32 v59, 1.0, v59
    v_add_f32 v60, 1.0, v60
    v_add_f32 v61, 1.0, v61
    v_add_f32 v62, 1.0, v62
    v_add_f32 v63, 1.0, v63
    v_fma_f32 v56, v48, v56, v56
    v_fma_f32 v57, v49, v57, v57
    v_fma_f32 v58, v50, v58, v58
    v_fma_f32 v59, v51, v59, v59
    v_fma_f32 v60, v52, v60, v60
    v_fma_f32 v61, v53, v61, v61
    v_fma_f32 v62, v54, v62, v62
    v_fma_f32 v63, v55, v63, v63
    v_rcp_f32 v56, v56
    v_rcp_f32 v57, v57
    v_rcp_f32 v58, v58
    v_rcp_f32 v59, v59
    v_rcp_f32 v60, v60
    v_rcp_f32 v61, v61
    v_rcp_f32 v62, v62
    v_rcp_f32 v63, v63
    v_fma_f32 v48, v48, v56, -v56
    v_fma_f32 v49, v49, v57, -v57
    v_fma_f32 v50, v50, v58, -v58
    v_fma_f32 v51, v51, v59, -v59
    v_fma_f32 v52, v52, v60, -v60
    v_fma_f32 v53, v53, v61, -v61
    v_fma_f32 v54, v54, v62, -v62
    v_fma_f32 v55, v55, v63, -v63
    v_cvt_pk_bf16_f32 v92, v48, v49
    v_cvt_pk_bf16_f32 v93, v50, v51
    v_cvt_pk_bf16_f32 v94, v52, v53
    v_cvt_pk_bf16_f32 v95, v54, v55
    ds_write_b128 v252, v[92:95] offset:1024
    ds_read_b64_tr_b16 v[100:101], v241 offset:36864
    ds_read_b64_tr_b16 v[104:105], v241 offset:36896
    ds_read_b64_tr_b16 v[108:109], v241 offset:36928
    ds_read_b64_tr_b16 v[112:113], v241 offset:36960
    ds_read_b64_tr_b16 v[116:117], v241 offset:36992
    ds_read_b64_tr_b16 v[120:121], v241 offset:37024
    ds_read_b64_tr_b16 v[124:125], v241 offset:37056
    ds_read_b64_tr_b16 v[128:129], v241 offset:37088
    ds_read_b64_tr_b16 v[132:133], v241 offset:37120
    ds_read_b64_tr_b16 v[136:137], v238 offset:0
    ds_read_b64_tr_b16 v[138:139], v238 offset:4608
    ds_read_b64_tr_b16 v[140:141], v238 offset:32
    ds_read_b64_tr_b16 v[142:143], v238 offset:4640
    ds_read_b64_tr_b16 v[144:145], v238 offset:64
    ds_read_b64_tr_b16 v[146:147], v238 offset:4672
    ds_read_b64_tr_b16 v[148:149], v238 offset:96
    ds_read_b64_tr_b16 v[150:151], v238 offset:4704
    ds_read_b64_tr_b16 v[152:153], v238 offset:128
    ds_read_b64_tr_b16 v[154:155], v238 offset:4736
    v_pk_mul_f32 v[0:1], v[0:1], s[40:41]
    v_pk_mul_f32 v[8:9], v[8:9], s[42:43]
    v_pk_mul_f32 v[2:3], v[2:3], s[40:41]
    v_pk_mul_f32 v[10:11], v[10:11], s[42:43]
    v_pk_mul_f32 v[4:5], v[4:5], s[40:41]
    v_pk_mul_f32 v[12:13], v[12:13], s[42:43]
    v_pk_mul_f32 v[6:7], v[6:7], s[40:41]
    v_pk_mul_f32 v[14:15], v[14:15], s[42:43]
    s_waitcnt lgkmcnt(9)
    s_barrier
    ds_read_b128 v[64:67], v253 offset:1024
    ds_read_b128 v[68:71], v253 offset:2048
    ds_read_b128 v[72:75], v253 offset:3072
    v_exp_f32 v8, v8
    v_exp_f32 v9, v9
    v_exp_f32 v10, v10
    v_exp_f32 v11, v11
    v_exp_f32 v12, v12
    v_exp_f32 v13, v13
    v_exp_f32 v14, v14
    v_exp_f32 v15, v15
    v_exp_f32 v0, v0
    v_exp_f32 v1, v1
    v_exp_f32 v2, v2
    v_exp_f32 v3, v3
    v_exp_f32 v4, v4
    v_exp_f32 v5, v5
    v_exp_f32 v6, v6
    v_exp_f32 v7, v7
    v_pk_add_f32 v[8:9], v[8:9], 1.0 op_sel_hi:[1,0]
    v_pk_add_f32 v[10:11], v[10:11], 1.0 op_sel_hi:[1,0]
    v_pk_add_f32 v[12:13], v[12:13], 1.0 op_sel_hi:[1,0]
    v_pk_add_f32 v[14:15], v[14:15], 1.0 op_sel_hi:[1,0]
    v_pk_fma_f32 v[8:9], v[0:1], v[8:9], v[8:9]
    v_pk_fma_f32 v[10:11], v[2:3], v[10:11], v[10:11]
    v_pk_fma_f32 v[12:13], v[4:5], v[12:13], v[12:13]
    v_pk_fma_f32 v[14:15], v[6:7], v[14:15], v[14:15]
    v_rcp_f32 v8, v8
    v_rcp_f32 v9, v9
    v_rcp_f32 v10, v10
    v_rcp_f32 v11, v11
    v_rcp_f32 v12, v12
    v_rcp_f32 v13, v13
    v_rcp_f32 v14, v14
    v_rcp_f32 v15, v15
    v_pk_fma_f32 v[0:1], v[0:1], v[8:9], v[8:9] neg_lo:[0,0,1] neg_hi:[0,0,1]
    v_pk_fma_f32 v[2:3], v[2:3], v[10:11], v[10:11] neg_lo:[0,0,1] neg_hi:[0,0,1]
    v_pk_fma_f32 v[4:5], v[4:5], v[12:13], v[12:13] neg_lo:[0,0,1] neg_hi:[0,0,1]
    v_pk_fma_f32 v[6:7], v[6:7], v[14:15], v[14:15] neg_lo:[0,0,1] neg_hi:[0,0,1]
    v_cvt_pk_bf16_f32 v80, v0, v1
    v_cvt_pk_bf16_f32 v81, v2, v3
    v_cvt_pk_bf16_f32 v82, v4, v5
    v_cvt_pk_bf16_f32 v83, v6, v7
L_m_Ug:
    v_mfma_f32_16x16x16_bf16 v[16:19], v[100:101], v[96:97], 0
    ds_read_b64_tr_b16 v[100:101], v238 offset:160
    v_mfma_f32_16x16x16_bf16 v[20:23], v[104:105], v[96:97], 0
    ds_read_b64_tr_b16 v[102:103], v238 offset:4768
    ds_read_b64_tr_b16 v[104:105], v238 offset:192
    v_mfma_f32_16x16x16_bf16 v[24:27], v[108:109], v[96:97], 0
    ds_read_b64_tr_b16 v[106:107], v238 offset:4800
    ds_read_b64_tr_b16 v[108:109], v238 offset:224
    v_mfma_f32_16x16x16_bf16 v[28:31], v[112:113], v[96:97], 0
    ds_read_b64_tr_b16 v[110:111], v238 offset:4832
    ds_read_b64_tr_b16 v[112:113], v238 offset:256
    v_mfma_f32_16x16x16_bf16 v[32:35], v[116:117], v[96:97], 0
    ds_read_b64_tr_b16 v[114:115], v238 offset:4864
    ds_read_b64_tr_b16 v[116:117], v239 offset:0
    v_mfma_f32_16x16x16_bf16 v[36:39], v[120:121], v[96:97], 0
    ds_read_b64_tr_b16 v[118:119], v239 offset:4608
    ds_read_b64_tr_b16 v[120:121], v236 offset:0
    v_mfma_f32_16x16x16_bf16 v[40:43], v[124:125], v[96:97], 0
    ds_read_b64_tr_b16 v[122:123], v236 offset:4608
    ds_read_b64_tr_b16 v[124:125], v249 offset:0
    v_mfma_f32_16x16x16_bf16 v[44:47], v[128:129], v[96:97], 0
    ds_read_b64_tr_b16 v[126:127], v249 offset:4608
    ds_read_b64_tr_b16 v[128:129], v239 offset:32
    v_mfma_f32_16x16x16_bf16 v[48:51], v[132:133], v[96:97], 0
    ds_read_b64_tr_b16 v[130:131], v239 offset:4640
    ds_read_b64_tr_b16 v[132:133], v236 offset:32
    s_waitcnt lgkmcnt(8)
    v_mfma_f32_16x16x32_bf16 v[16:19], v[136:139], v[64:67], v[16:19]
    ds_read_b64_tr_b16 v[134:135], v236 offset:4640
    ds_read_b64_tr_b16 v[136:137], v249 offset:32
    v_mfma_f32_16x16x32_bf16 v[20:23], v[140:143], v[64:67], v[20:23]
    ds_read_b64_tr_b16 v[138:139], v249 offset:4640
    ds_read_b64_tr_b16 v[140:141], v239 offset:64
    v_mfma_f32_16x16x32_bf16 v[24:27], v[144:147], v[64:67], v[24:27]
    ds_read_b64_tr_b16 v[142:143], v239 offset:4672
    ds_read_b64_tr_b16 v[144:145], v236 offset:64
    v_mfma_f32_16x16x32_bf16 v[28:31], v[148:151], v[64:67], v[28:31]
    ds_read_b64_tr_b16 v[146:147], v236 offset:4672
    ds_read_b64_tr_b16 v[148:149], v249 offset:64
    v_mfma_f32_16x16x32_bf16 v[32:35], v[152:155], v[64:67], v[32:35]
    ds_read_b64_tr_b16 v[150:151], v249 offset:4672
    ds_read_b64_tr_b16 v[152:153], v239 offset:96
    v_mfma_f32_16x16x32_bf16 v[36:39], v[100:103], v[64:67], v[36:39]
    ds_read_b64_tr_b16 v[154:155], v239 offset:4704
    ds_read_b64_tr_b16 v[100:101], v236 offset:96
    v_mfma_f32_16x16x32_bf16 v[40:43], v[104:107], v[64:67], v[40:43]
    ds_read_b64_tr_b16 v[102:103], v236 offset:4704
    ds_read_b64_tr_b16 v[104:105], v249 offset:96
    v_mfma_f32_16x16x32_bf16 v[44:47], v[108:111], v[64:67], v[44:47]
    ds_read_b64_tr_b16 v[106:107], v249 offset:4704
    ds_read_b64_tr_b16 v[108:109], v239 offset:128
    v_mfma_f32_16x16x32_bf16 v[48:51], v[112:115], v[64:67], v[48:51]
    ds_read_b64_tr_b16 v[110:111], v239 offset:4736
    ds_read_b64_tr_b16 v[112:113], v236 offset:128
    s_waitcnt lgkmcnt(8)
    v_mfma_f32_16x16x32_bf16 v[16:19], v[116:119], v[68:71], v[16:19]
    ds_read_b64_tr_b16 v[114:115], v236 offset:4736
    ds_read_b64_tr_b16 v[116:117], v249 offset:128
    v_mfma_f32_16x16x32_bf16 v[16:19], v[120:123], v[72:75], v[16:19]
    ds_read_b64_tr_b16 v[118:119], v249 offset:4736
    ds_read_b64_tr_b16 v[120:121], v239 offset:160
    v_mfma_f32_16x16x32_bf16 v[16:19], v[124:127], v[80:83], v[16:19]
    ds_read_b64_tr_b16 v[122:123], v239 offset:4768
    ds_read_b64_tr_b16 v[124:125], v236 offset:160
    v_mfma_f32_16x16x32_bf16 v[20:23], v[128:131], v[68:71], v[20:23]
    ds_read_b64_tr_b16 v[126:127], v236 offset:4768
    ds_read_b64_tr_b16 v[128:129], v249 offset:160
    v_mfma_f32_16x16x32_bf16 v[20:23], v[132:135], v[72:75], v[20:23]
    ds_read_b64_tr_b16 v[130:131], v249 offset:4768
    ds_read_b64_tr_b16 v[132:133], v239 offset:192
    v_mfma_f32_16x16x32_bf16 v[20:23], v[136:139], v[80:83], v[20:23]
    v_cvt_pk_bf16_f32 v0, v16, v17
    v_cvt_pk_bf16_f32 v1, v18, v19
    v_mfma_f32_16x16x32_bf16 v[24:27], v[140:143], v[68:71], v[24:27]
    ds_write_b64 v242, v[0:1] offset:0
    v_mfma_f32_16x16x32_bf16 v[24:27], v[144:147], v[72:75], v[24:27]
    ds_read_b64_tr_b16 v[134:135], v239 offset:4800
    ds_read_b64_tr_b16 v[136:137], v236 offset:192
    v_mfma_f32_16x16x32_bf16 v[24:27], v[148:151], v[80:83], v[24:27]
    v_cvt_pk_bf16_f32 v2, v20, v21
    v_cvt_pk_bf16_f32 v3, v22, v23
    s_waitcnt lgkmcnt(8)
    v_mfma_f32_16x16x32_bf16 v[28:31], v[152:155], v[68:71], v[28:31]
    ds_write_b64 v242, v[2:3] offset:32
    v_mfma_f32_16x16x32_bf16 v[28:31], v[100:103], v[72:75], v[28:31]
    ds_read_b64_tr_b16 v[138:139], v236 offset:4800
    ds_read_b64_tr_b16 v[140:141], v249 offset:192
    v_mfma_f32_16x16x32_bf16 v[28:31], v[104:107], v[80:83], v[28:31]
    ds_read_b64_tr_b16 v[142:143], v249 offset:4800
    ds_read_b64_tr_b16 v[144:145], v239 offset:224
    v_mfma_f32_16x16x32_bf16 v[32:35], v[108:111], v[68:71], v[32:35]
    ds_read_b64_tr_b16 v[146:147], v239 offset:4832
    ds_read_b64_tr_b16 v[148:149], v236 offset:224
    v_mfma_f32_16x16x32_bf16 v[32:35], v[112:115], v[72:75], v[32:35]
    ds_read_b64_tr_b16 v[150:151], v236 offset:4832
    ds_read_b64_tr_b16 v[152:153], v249 offset:224
    v_mfma_f32_16x16x32_bf16 v[32:35], v[116:119], v[80:83], v[32:35]
    ds_read_b64_tr_b16 v[154:155], v249 offset:4832
    ds_read_b64_tr_b16 v[100:101], v239 offset:256
    v_mfma_f32_16x16x32_bf16 v[36:39], v[120:123], v[68:71], v[36:39]
    ds_read_b64_tr_b16 v[102:103], v239 offset:4864
    ds_read_b64_tr_b16 v[104:105], v236 offset:256
    s_waitcnt lgkmcnt(8)
    v_mfma_f32_16x16x32_bf16 v[36:39], v[124:127], v[72:75], v[36:39]
    ds_read_b64_tr_b16 v[106:107], v236 offset:4864
    ds_read_b64_tr_b16 v[108:109], v249 offset:256
    v_mfma_f32_16x16x32_bf16 v[36:39], v[128:131], v[80:83], v[36:39]
    ds_read_b64_tr_b16 v[110:111], v249 offset:4864
    v_mfma_f32_16x16x32_bf16 v[40:43], v[132:135], v[68:71], v[40:43]
    v_cvt_pk_bf16_f32 v4, v24, v25
    v_cvt_pk_bf16_f32 v5, v26, v27
    v_mfma_f32_16x16x32_bf16 v[40:43], v[136:139], v[72:75], v[40:43]
    ds_write_b64 v242, v[4:5] offset:64
    v_mfma_f32_16x16x32_bf16 v[40:43], v[140:143], v[80:83], v[40:43]
    v_cvt_pk_bf16_f32 v6, v28, v29
    v_cvt_pk_bf16_f32 v7, v30, v31
    s_waitcnt lgkmcnt(11)
    v_mfma_f32_16x16x32_bf16 v[44:47], v[144:147], v[68:71], v[44:47]
    ds_write_b64 v242, v[6:7] offset:96
    s_waitcnt lgkmcnt(10)
    v_mfma_f32_16x16x32_bf16 v[44:47], v[148:151], v[72:75], v[44:47]
    v_cvt_pk_bf16_f32 v8, v32, v33
    v_cvt_pk_bf16_f32 v9, v34, v35
    s_waitcnt lgkmcnt(8)
    v_mfma_f32_16x16x32_bf16 v[44:47], v[152:155], v[80:83], v[44:47]
    ds_write_b64 v242, v[8:9] offset:128
    s_waitcnt lgkmcnt(7)
    v_mfma_f32_16x16x32_bf16 v[48:51], v[100:103], v[68:71], v[48:51]
    v_cvt_pk_bf16_f32 v10, v36, v37
    v_cvt_pk_bf16_f32 v11, v38, v39
    s_waitcnt lgkmcnt(5)
    v_mfma_f32_16x16x32_bf16 v[48:51], v[104:107], v[72:75], v[48:51]
    ds_write_b64 v242, v[10:11] offset:160
    s_waitcnt lgkmcnt(4)
    v_mfma_f32_16x16x32_bf16 v[48:51], v[108:111], v[80:83], v[48:51]
    v_cvt_pk_bf16_f32 v12, v40, v41
    v_cvt_pk_bf16_f32 v13, v42, v43
    ds_write_b64 v242, v[12:13] offset:192
    v_cvt_pk_bf16_f32 v14, v44, v45
    v_cvt_pk_bf16_f32 v15, v46, v47
    ds_write_b64 v242, v[14:15] offset:224
    s_nop 1
    v_cvt_pk_bf16_f32 v52, v48, v49
    v_cvt_pk_bf16_f32 v53, v50, v51
    ds_write_b64 v242, v[52:53] offset:256
    ds_read_b128 v[16:19], v243 offset:0
L_wp2:
    s_cbranch_execz L_wback
    ds_read_b128 v[20:23], v243 offset:1024
    ds_read_b128 v[24:27], v243 offset:2048
    ds_read_b128 v[28:31], v243 offset:3072
    ds_read_b128 v[32:35], v243 offset:4096
    s_waitcnt lgkmcnt(4)
    buffer_store_dwordx4 v[16:19], v244, s[28:31], 0 offen sc1
    s_waitcnt lgkmcnt(3)
    buffer_store_dwordx4 v[20:23], v245, s[28:31], 0 offen sc1
    s_waitcnt lgkmcnt(2)
    buffer_store_dwordx4 v[24:27], v246, s[28:31], 0 offen sc1
    s_waitcnt lgkmcnt(1)
    buffer_store_dwordx4 v[28:31], v247, s[28:31], 0 offen sc1
    s_waitcnt lgkmcnt(0)
    s_mov_b32 exec_hi, 0
    buffer_store_dwordx4 v[32:35], v248, s[28:31], 0 offen sc1
    s_mov_b32 exec_hi, -1
    s_barrier
    s_endpgm
L_V:
    s_add_u32 m0, s53, 39168
    s_add_u32 s54, s53, 18432
    buffer_load_dwordx4 v236, s[20:23], s54 offen offset:0  lds
    buffer_load_dwordx4 v236, s[20:23], s54 offen offset:1024  lds
    buffer_load_dwordx4 v236, s[20:23], s54 offen offset:2048  lds
    s_add_u32 m0, s52, 39168
    s_add_u32 s54, s52, 18432
    buffer_load_dwordx4 v236, s[20:23], s54 offen offset:0  lds
    s_mov_b32 exec_hi, 0
    buffer_load_dwordx4 v236, s[20:23], s54 offen offset:1024  lds
    s_mov_b32 exec_hi, -1
    s_add_u32 m0, s53, 57600
    s_add_u32 s54, s53, 36864
    buffer_load_dwordx4 v236, s[20:23], s54 offen offset:0  lds
    buffer_load_dwordx4 v236, s[20:23], s54 offen offset:1024  lds
    buffer_load_dwordx4 v236, s[20:23], s54 offen offset:2048  lds
    s_add_u32 m0, s52, 57600
    s_add_u32 s54, s52, 36864
    buffer_load_dwordx4 v236, s[20:23], s54 offen offset:0  lds
    s_mov_b32 exec_hi, 0
    buffer_load_dwordx4 v236, s[20:23], s54 offen offset:1024  lds
    s_mov_b32 exec_hi, -1
    ds_read_b64_tr_b16 v[80:81], v234 offset:36864
    ds_read_b64_tr_b16 v[82:83], v234 offset:39168
    ds_read_b64_tr_b16 v[84:85], v235 offset:36896
    ds_read_b64_tr_b16 v[86:87], v235 offset:39200
    ds_read_b64_tr_b16 v[88:89], v235 offset:37152
    ds_read_b64_tr_b16 v[90:91], v235 offset:39456
    ds_read_b64_tr_b16 v[92:93], v234 offset:37184
    ds_read_b64_tr_b16 v[94:95], v234 offset:39488
    s_waitcnt vmcnt(10)
    s_barrier
L_m_V0:
    ds_read_b128 v[64:67], v224 offset:2304
    ds_read_b128 v[68:71], v225 offset:2304
    ds_read_b128 v[72:75], v226 offset:2304
    ds_read_b128 v[76:79], v227 offset:2304
    s_waitcnt lgkmcnt(3)
    v_mfma_f32_16x16x32_bf16 v[0:3], v[80:83], v[64:67], 0
    v_mfma_f32_16x16x32_bf16 v[4:7], v[84:87], v[64:67], 0
    v_mfma_f32_16x16x32_bf16 v[8:11], v[88:91], v[64:67], 0
    v_mfma_f32_16x16x32_bf16 v[12:15], v[92:95], v[64:67], 0
    ds_read_b128 v[64:67], v224 offset:2368
    s_waitcnt lgkmcnt(3)
    v_mfma_f32_16x16x32_bf16 v[16:19], v[80:83], v[68:71], 0
    v_mfma_f32_16x16x32_bf16 v[20:23], v[84:87], v[68:71], 0
    v_mfma_f32_16x16x32_bf16 v[24:27], v[88:91], v[68:71], 0
    v_mfma_f32_16x16x32_bf16 v[28:31], v[92:95], v[68:71], 0
    ds_read_b128 v[68:71], v225 offset:2368
    s_waitcnt lgkmcnt(3)
    v_mfma_f32_16x16x32_bf16 v[32:35], v[80:83], v[72:75], 0
    v_mfma_f32_16x16x32_bf16 v[36:39], v[84:87], v[72:75], 0
    v_mfma_f32_16x16x32_bf16 v[40:43], v[88:91], v[72:75], 0
    v_mfma_f32_16x16x32_bf16 v[44:47], v[92:95], v[72:75], 0
    ds_read_b128 v[72:75], v226 offset:2368
    s_waitcnt lgkmcnt(3)
    v_mfma_f32_16x16x32_bf16 v[48:51], v[80:83], v[76:79], 0
    v_mfma_f32_16x16x32_bf16 v[52:55], v[84:87], v[76:79], 0
    v_mfma_f32_16x16x32_bf16 v[56:59], v[88:91], v[76:79], 0
    v_mfma_f32_16x16x32_bf16 v[60:63], v[92:95], v[76:79], 0
    ds_read_b128 v[76:79], v227 offset:2368
    s_waitcnt vmcnt(5)
    s_barrier
L_m_V1:
    s_add_u32 m0, s53, 94464
    s_add_u32 s54, s53, 73728
    buffer_load_dwordx4 v236, s[20:23], s54 offen offset:0  lds
    buffer_load_dwordx4 v236, s[20:23], s54 offen offset:1024  lds
    buffer_load_dwordx4 v236, s[20:23], s54 offen offset:2048  lds
    s_add_u32 m0, s53, 112896
    s_add_u32 s54, s53, 92160
    buffer_load_dwordx4 v236, s[20:23], s54 offen offset:0  lds
    buffer_load_dwordx4 v236, s[20:23], s54 offen offset:1024  lds
    ds_read_b64_tr_b16 v[96:97], v232 offset:0
    ds_read_b64_tr_b16 v[98:99], v232 offset:2304
    ds_read_b64_tr_b16 v[100:101], v233 offset:32
    ds_read_b64_tr_b16 v[102:103], v233 offset:2336
    ds_read_b64_tr_b16 v[104:105], v233 offset:288
    ds_read_b64_tr_b16 v[106:107], v233 offset:2592
    ds_read_b64_tr_b16 v[108:109], v232 offset:320
    ds_read_b64_tr_b16 v[110:111], v232 offset:2624
    s_waitcnt lgkmcnt(6)
    v_mfma_f32_16x16x32_bf16 v[0:3], v[96:99], v[64:67], v[0:3]
    s_waitcnt lgkmcnt(4)
    v_mfma_f32_16x16x32_bf16 v[4:7], v[100:103], v[64:67], v[4:7]
    s_waitcnt lgkmcnt(2)
    v_mfma_f32_16x16x32_bf16 v[8:11], v[104:107], v[64:67], v[8:11]
    s_waitcnt lgkmcnt(0)
    v_mfma_f32_16x16x32_bf16 v[12:15], v[108:111], v[64:67], v[12:15]
    ds_read_b128 v[64:67], v224 offset:2432
    v_mfma_f32_16x16x32_bf16 v[16:19], v[96:99], v[68:71], v[16:19]
    v_mfma_f32_16x16x32_bf16 v[20:23], v[100:103], v[68:71], v[20:23]
    v_mfma_f32_16x16x32_bf16 v[24:27], v[104:107], v[68:71], v[24:27]
    v_mfma_f32_16x16x32_bf16 v[28:31], v[108:111], v[68:71], v[28:31]
    ds_read_b128 v[68:71], v225 offset:2432
    s_waitcnt vmcnt(5)
    s_barrier
L_m_V2:
    buffer_load_dwordx4 v236, s[20:23], s54 offen offset:2048  lds
    s_add_u32 m0, s53, 131328
    s_add_u32 s54, s53, 110592
    buffer_load_dwordx4 v236, s[20:23], s54 offen offset:0  lds
    buffer_load_dwordx4 v236, s[20:23], s54 offen offset:1024  lds
    buffer_load_dwordx4 v236, s[20:23], s54 offen offset:2048  lds
    ds_read_b64_tr_b16 v[112:113], v232 offset:18432
    ds_read_b64_tr_b16 v[114:115], v232 offset:20736
    v_mfma_f32_16x16x32_bf16 v[32:35], v[96:99], v[72:75], v[32:35]
    ds_read_b64_tr_b16 v[116:117], v233 offset:18464
    v_mfma_f32_16x16x32_bf16 v[36:39], v[100:103], v[72:75], v[36:39]
    ds_read_b64_tr_b16 v[118:119], v233 offset:20768
    v_mfma_f32_16x16x32_bf16 v[40:43], v[104:107], v[72:75], v[40:43]
    ds_read_b64_tr_b16 v[120:121], v233 offset:18720
    v_mfma_f32_16x16x32_bf16 v[44:47], v[108:111], v[72:75], v[44:47]
    ds_read_b128 v[72:75], v226 offset:2432
    v_mfma_f32_16x16x32_bf16 v[48:51], v[96:99], v[76:79], v[48:51]
    ds_read_b64_tr_b16 v[122:123], v233 offset:21024
    v_mfma_f32_16x16x32_bf16 v[52:55], v[100:103], v[76:79], v[52:55]
    ds_read_b64_tr_b16 v[124:125], v232 offset:18752
    v_mfma_f32_16x16x32_bf16 v[56:59], v[104:107], v[76:79], v[56:59]
    ds_read_b64_tr_b16 v[126:127], v232 offset:21056
    v_mfma_f32_16x16x32_bf16 v[60:63], v[108:111], v[76:79], v[60:63]
    ds_read_b128 v[76:79], v227 offset:2432
    s_barrier
L_m_V3:
    s_add_u32 m0, s53, 39168
    s_add_u32 s54, s53, 129024
    buffer_load_dwordx4 v236, s[20:23], s54 offen offset:0  lds
    buffer_load_dwordx4 v236, s[20:23], s54 offen offset:1024  lds
    buffer_load_dwordx4 v236, s[20:23], s54 offen offset:2048  lds
    ds_read_b64_tr_b16 v[128:129], v232 offset:36864
    ds_read_b64_tr_b16 v[130:131], v232 offset:39168
    s_waitcnt lgkmcnt(10)
    v_mfma_f32_16x16x32_bf16 v[0:3], v[112:115], v[64:67], v[0:3]
    ds_read_b64_tr_b16 v[132:133], v233 offset:36896
    s_waitcnt lgkmcnt(9)
    v_mfma_f32_16x16x32_bf16 v[4:7], v[116:119], v[64:67], v[4:7]
    ds_read_b64_tr_b16 v[134:135], v233 offset:39200
    s_waitcnt lgkmcnt(7)
    v_mfma_f32_16x16x32_bf16 v[8:11], v[120:123], v[64:67], v[8:11]
    ds_read_b64_tr_b16 v[136:137], v233 offset:37152
    s_waitcnt lgkmcnt(6)
    v_mfma_f32_16x16x32_bf16 v[12:15], v[124:127], v[64:67], v[12:15]
    ds_read_b128 v[64:67], v224 offset:2496
    v_mfma_f32_16x16x32_bf16 v[16:19], v[112:115], v[68:71], v[16:19]
    ds_read_b64_tr_b16 v[138:139], v233 offset:39456
    v_mfma_f32_16x16x32_bf16 v[20:23], v[116:119], v[68:71], v[20:23]
    ds_read_b64_tr_b16 v[140:141], v232 offset:37184
    v_mfma_f32_16x16x32_bf16 v[24:27], v[120:123], v[68:71], v[24:27]
    ds_read_b64_tr_b16 v[142:143], v232 offset:39488
    v_mfma_f32_16x16x32_bf16 v[28:31], v[124:127], v[68:71], v[28:31]
    ds_read_b128 v[68:71], v225 offset:2496
    s_waitcnt vmcnt(9)
    s_barrier
L_m_V4:
    s_add_u32 m0, s53, 57600
    s_add_u32 s54, s53, 147456
    buffer_load_dwordx4 v236, s[20:23], s54 offen offset:0  lds
    buffer_load_dwordx4 v236, s[20:23], s54 offen offset:1024  lds
    buffer_load_dwordx4 v236, s[20:23], s54 offen offset:2048  lds
    ds_read_b64_tr_b16 v[144:145], v234 offset:0
    ds_read_b64_tr_b16 v[146:147], v234 offset:2304
    v_mfma_f32_16x16x32_bf16 v[32:35], v[112:115], v[72:75], v[32:35]
    ds_read_b64_tr_b16 v[148:149], v235 offset:32
    v_mfma_f32_16x16x32_bf16 v[36:39], v[116:119], v[72:75], v[36:39]
    ds_read_b64_tr_b16 v[150:151], v235 offset:2336
    v_mfma_f32_16x16x32_bf16 v[40:43], v[120:123], v[72:75], v[40:43]
    ds_read_b64_tr_b16 v[152:153], v235 offset:288
    v_mfma_f32_16x16x32_bf16 v[44:47], v[124:127], v[72:75], v[44:47]
    ds_read_b128 v[72:75], v226 offset:2496
    s_waitcnt lgkmcnt(9)
    v_mfma_f32_16x16x32_bf16 v[48:51], v[112:115], v[76:79], v[48:51]
    ds_read_b64_tr_b16 v[154:155], v235 offset:2592
    v_mfma_f32_16x16x32_bf16 v[52:55], v[116:119], v[76:79], v[52:55]
    ds_read_b64_tr_b16 v[156:157], v234 offset:320
    v_mfma_f32_16x16x32_bf16 v[56:59], v[120:123], v[76:79], v[56:59]
    ds_read_b64_tr_b16 v[158:159], v234 offset:2624
    v_mfma_f32_16x16x32_bf16 v[60:63], v[124:127], v[76:79], v[60:63]
    ds_read_b128 v[76:79], v227 offset:2496
    s_waitcnt lgkmcnt(11)
    s_waitcnt vmcnt(9)
    s_barrier
L_m_V5:
    s_add_u32 m0, s53, 76032
    s_add_u32 s54, s53, 165888
    buffer_load_dwordx4 v236, s[20:23], s54 offen offset:0  lds
    buffer_load_dwordx4 v236, s[20:23], s54 offen offset:1024  lds
    buffer_load_dwordx4 v236, s[20:23], s54 offen offset:2048  lds
    ds_read_b64_tr_b16 v[160:161], v234 offset:18432
    ds_read_b64_tr_b16 v[162:163], v234 offset:20736
    v_mfma_f32_16x16x32_bf16 v[0:3], v[128:131], v[64:67], v[0:3]
    ds_read_b64_tr_b16 v[164:165], v235 offset:18464
    v_mfma_f32_16x16x32_bf16 v[4:7], v[132:135], v[64:67], v[4:7]
    ds_read_b64_tr_b16 v[166:167], v235 offset:20768
    v_mfma_f32_16x16x32_bf16 v[8:11], v[136:139], v[64:67], v[8:11]
    ds_read_b64_tr_b16 v[168:169], v235 offset:18720
    v_mfma_f32_16x16x32_bf16 v[12:15], v[140:143], v[64:67], v[12:15]
    ds_read_b128 v[64:67], v228 offset:1728
    s_waitcnt lgkmcnt(9)
    v_mfma_f32_16x16x32_bf16 v[16:19], v[128:131], v[68:71], v[16:19]
    ds_read_b64_tr_b16 v[170:171], v235 offset:21024
    v_mfma_f32_16x16x32_bf16 v[20:23], v[132:135], v[68:71], v[20:23]
    ds_read_b64_tr_b16 v[172:173], v234 offset:18752
    v_mfma_f32_16x16x32_bf16 v[24:27], v[136:139], v[68:71], v[24:27]
    ds_read_b64_tr_b16 v[174:175], v234 offset:21056
    v_mfma_f32_16x16x32_bf16 v[28:31], v[140:143], v[68:71], v[28:31]
    ds_read_b128 v[68:71], v229 offset:1728
    s_waitcnt lgkmcnt(11)
    s_waitcnt vmcnt(9)
    s_barrier
L_m_V6:
    s_add_u32 m0, s53, 94464
    s_add_u32 s54, s53, 184320
    buffer_load_dwordx4 v236, s[20:23], s54 offen offset:0  lds
    buffer_load_dwordx4 v236, s[20:23], s54 offen offset:1024  lds
    buffer_load_dwordx4 v236, s[20:23], s54 offen offset:2048  lds
    ds_read_b64_tr_b16 v[176:177], v234 offset:36864
    ds_read_b64_tr_b16 v[178:179], v234 offset:39168
    v_mfma_f32_16x16x32_bf16 v[32:35], v[128:131], v[72:75], v[32:35]
    ds_read_b64_tr_b16 v[180:181], v235 offset:36896
    v_mfma_f32_16x16x32_bf16 v[36:39], v[132:135], v[72:75], v[36:39]
    ds_read_b64_tr_b16 v[182:183], v235 offset:39200
    v_mfma_f32_16x16x32_bf16 v[40:43], v[136:139], v[72:75], v[40:43]
    ds_read_b64_tr_b16 v[184:185], v235 offset:37152
    v_mfma_f32_16x16x32_bf16 v[44:47], v[140:143], v[72:75], v[44:47]
    ds_read_b128 v[72:75], v230 offset:1728
    s_waitcnt lgkmcnt(9)
    v_mfma_f32_16x16x32_bf16 v[48:51], v[128:131], v[76:79], v[48:51]
    ds_read_b64_tr_b16 v[186:187], v235 offset:39456
    v_mfma_f32_16x16x32_bf16 v[52:55], v[132:135], v[76:79], v[52:55]
    ds_read_b64_tr_b16 v[188:189], v234 offset:37184
    v_mfma_f32_16x16x32_bf16 v[56:59], v[136:139], v[76:79], v[56:59]
    ds_read_b64_tr_b16 v[190:191], v234 offset:39488
    v_mfma_f32_16x16x32_bf16 v[60:63], v[140:143], v[76:79], v[60:63]
    ds_read_b128 v[76:79], v231 offset:1728
    s_waitcnt lgkmcnt(11)
    s_waitcnt vmcnt(9)
    s_barrier
L_m_V7:
    s_add_u32 m0, s53, 112896
    s_add_u32 s54, s53, 202752
    buffer_load_dwordx4 v236, s[20:23], s54 offen offset:0  lds
    buffer_load_dwordx4 v236, s[20:23], s54 offen offset:1024  lds
    buffer_load_dwordx4 v236, s[20:23], s54 offen offset:2048  lds
    ds_read_b64_tr_b16 v[192:193], v232 offset:0
    ds_read_b64_tr_b16 v[194:195], v232 offset:2304
    v_mfma_f32_16x16x32_bf16 v[0:3], v[144:147], v[64:67], v[0:3]
    ds_read_b64_tr_b16 v[196:197], v233 offset:32
    v_mfma_f32_16x16x32_bf16 v[4:7], v[148:151], v[64:67], v[4:7]
    ds_read_b64_tr_b16 v[198:199], v233 offset:2336
    v_mfma_f32_16x16x32_bf16 v[8:11], v[152:155], v[64:67], v[8:11]
    ds_read_b64_tr_b16 v[200:201], v233 offset:288
    v_mfma_f32_16x16x32_bf16 v[12:15], v[156:159], v[64:67], v[12:15]
    ds_read_b128 v[64:67], v224 offset:1760
    s_waitcnt lgkmcnt(9)
    v_mfma_f32_16x16x32_bf16 v[16:19], v[144:147], v[68:71], v[16:19]
    ds_read_b64_tr_b16 v[202:203], v233 offset:2592
    v_mfma_f32_16x16x32_bf16 v[20:23], v[148:151], v[68:71], v[20:23]
    ds_read_b64_tr_b16 v[204:205], v232 offset:320
    v_mfma_f32_16x16x32_bf16 v[24:27], v[152:155], v[68:71], v[24:27]
    ds_read_b64_tr_b16 v[206:207], v232 offset:2624
    v_mfma_f32_16x16x32_bf16 v[28:31], v[156:159], v[68:71], v[28:31]
    ds_read_b128 v[68:71], v225 offset:1760
    s_waitcnt lgkmcnt(11)
    s_waitcnt vmcnt(9)
    s_barrier
L_m_V8:
    s_add_u32 m0, s53, 131328
    s_add_u32 s54, s53, 221184
    buffer_load_dwordx4 v236, s[20:23], s54 offen offset:0  lds
    buffer_load_dwordx4 v236, s[20:23], s54 offen offset:1024  lds
    buffer_load_dwordx4 v236, s[20:23], s54 offen offset:2048  lds
    ds_read_b64_tr_b16 v[208:209], v232 offset:18432
    ds_read_b64_tr_b16 v[210:211], v232 offset:20736
    v_mfma_f32_16x16x32_bf16 v[32:35], v[144:147], v[72:75], v[32:35]
    ds_read_b64_tr_b16 v[212:213], v233 offset:18464
    v_mfma_f32_16x16x32_bf16 v[36:39], v[148:151], v[72:75], v[36:39]
    ds_read_b64_tr_b16 v[214:215], v233 offset:20768
    v_mfma_f32_16x16x32_bf16 v[40:43], v[152:155], v[72:75], v[40:43]
    ds_read_b64_tr_b16 v[216:217], v233 offset:18720
    v_mfma_f32_16x16x32_bf16 v[44:47], v[156:159], v[72:75], v[44:47]
    ds_read_b128 v[72:75], v226 offset:1760
    s_waitcnt lgkmcnt(9)
    v_mfma_f32_16x16x32_bf16 v[48:51], v[144:147], v[76:79], v[48:51]
    ds_read_b64_tr_b16 v[218:219], v233 offset:21024
    v_mfma_f32_16x16x32_bf16 v[52:55], v[148:151], v[76:79], v[52:55]
    ds_read_b64_tr_b16 v[220:221], v232 offset:18752
    v_mfma_f32_16x16x32_bf16 v[56:59], v[152:155], v[76:79], v[56:59]
    ds_read_b64_tr_b16 v[222:223], v232 offset:21056
    v_mfma_f32_16x16x32_bf16 v[60:63], v[156:159], v[76:79], v[60:63]
    ds_read_b128 v[76:79], v227 offset:1760
    s_waitcnt lgkmcnt(11)
    s_waitcnt vmcnt(9)
    s_barrier
L_m_V9:
    s_add_u32 m0, s53, 39168
    s_add_u32 s54, s53, 239616
    buffer_load_dwordx4 v236, s[20:23], s54 offen offset:0  lds
    buffer_load_dwordx4 v236, s[20:23], s54 offen offset:1024  lds
    buffer_load_dwordx4 v236, s[20:23], s54 offen offset:2048  lds
    ds_read_b64_tr_b16 v[80:81], v232 offset:36864
    ds_read_b64_tr_b16 v[82:83], v232 offset:39168
    v_mfma_f32_16x16x32_bf16 v[0:3], v[160:163], v[64:67], v[0:3]
    ds_read_b64_tr_b16 v[84:85], v233 offset:36896
    v_mfma_f32_16x16x32_bf16 v[4:7], v[164:167], v[64:67], v[4:7]
    ds_read_b64_tr_b16 v[86:87], v233 offset:39200
    v_mfma_f32_16x16x32_bf16 v[8:11], v[168:171], v[64:67], v[8:11]
    ds_read_b64_tr_b16 v[88:89], v233 offset:37152
    v_mfma_f32_16x16x32_bf16 v[12:15], v[172:175], v[64:67], v[12:15]
    ds_read_b128 v[64:67], v224 offset:1824
    s_waitcnt lgkmcnt(9)
    v_mfma_f32_16x16x32_bf16 v[16:19], v[160:163], v[68:71], v[16:19]
    ds_read_b64_tr_b16 v[90:91], v233 offset:39456
    v_mfma_f32_16x16x32_bf16 v[20:23], v[164:167], v[68:71], v[20:23]
    ds_read_b64_tr_b16 v[92:93], v232 offset:37184
    v_mfma_f32_16x16x32_bf16 v[24:27], v[168:171], v[68:71], v[24:27]
    ds_read_b64_tr_b16 v[94:95], v232 offset:39488
    v_mfma_f32_16x16x32_bf16 v[28:31], v[172:175], v[68:71], v[28:31]
    ds_read_b128 v[68:71], v225 offset:1824
    s_waitcnt lgkmcnt(11)
    s_waitcnt vmcnt(9)
    s_barrier
L_m_V10:
    s_add_u32 m0, s53, 57600
    s_add_u32 s54, s53, 258048
    buffer_load_dwordx4 v236, s[20:23], s54 offen offset:0  lds
    buffer_load_dwordx4 v236, s[20:23], s54 offen offset:1024  lds
    buffer_load_dwordx4 v236, s[20:23], s54 offen offset:2048  lds
    ds_read_b64_tr_b16 v[96:97], v234 offset:0
    ds_read_b64_tr_b16 v[98:99], v234 offset:2304
    v_mfma_f32_16x16x32_bf16 v[32:35], v[160:163], v[72:75], v[32:35]
    ds_read_b64_tr_b16 v[100:101], v235 offset:32
    v_mfma_f32_16x16x32_bf16 v[36:39], v[164:167], v[72:75], v[36:39]
    ds_read_b64_tr_b16 v[102:103], v235 offset:2336
    v_mfma_f32_16x16x32_bf16 v[40:43], v[168:171], v[72:75], v[40:43]
    ds_read_b64_tr_b16 v[104:105], v235 offset:288
    v_mfma_f32_16x16x32_bf16 v[44:47], v[172:175], v[72:75], v[44:47]
    ds_read_b128 v[72:75], v226 offset:1824
    s_waitcnt lgkmcnt(9)
    v_mfma_f32_16x16x32_bf16 v[48:51], v[160:163], v[76:79], v[48:51]
    ds_read_b64_tr_b16 v[106:107], v235 offset:2592
    v_mfma_f32_16x16x32_bf16 v[52:55], v[164:167], v[76:79], v[52:55]
    ds_read_b64_tr_b16 v[108:109], v234 offset:320
    v_mfma_f32_16x16x32_bf16 v[56:59], v[168:171], v[76:79], v[56:59]
    ds_read_b64_tr_b16 v[110:111], v234 offset:2624
    v_mfma_f32_16x16x32_bf16 v[60:63], v[172:175], v[76:79], v[60:63]
    ds_read_b128 v[76:79], v227 offset:1824
    v_mfma_f32_16x16x32_bf16 v[0:3], v[176:179], v[64:67], v[0:3]
    s_waitcnt lgkmcnt(11)
    s_waitcnt vmcnt(9)
    s_barrier
L_m_V11:
    s_add_u32 m0, s53, 76032
    s_add_u32 s54, s53, 276480
    buffer_load_dwordx4 v236, s[20:23], s54 offen offset:0  lds
    buffer_load_dwordx4 v236, s[20:23], s54 offen offset:1024  lds
    buffer_load_dwordx4 v236, s[20:23], s54 offen offset:2048  lds
    ds_read_b64_tr_b16 v[112:113], v234 offset:18432
    ds_read_b64_tr_b16 v[114:115], v234 offset:20736
    v_mfma_f32_16x16x32_bf16 v[4:7], v[180:183], v[64:67], v[4:7]
    ds_read_b64_tr_b16 v[116:117], v235 offset:18464
    v_mfma_f32_16x16x32_bf16 v[8:11], v[184:187], v[64:67], v[8:11]
    ds_read_b64_tr_b16 v[118:119], v235 offset:20768
    v_mfma_f32_16x16x32_bf16 v[12:15], v[188:191], v[64:67], v[12:15]
    ds_read_b128 v[64:67], v224 offset:1888
    s_waitcnt lgkmcnt(9)
    v_mfma_f32_16x16x32_bf16 v[16:19], v[176:179], v[68:71], v[16:19]
    ds_read_b64_tr_b16 v[120:121], v235 offset:18720
    v_mfma_f32_16x16x32_bf16 v[20:23], v[180:183], v[68:71], v[20:23]
    ds_read_b64_tr_b16 v[122:123], v235 offset:21024
    v_mfma_f32_16x16x32_bf16 v[24:27], v[184:187], v[68:71], v[24:27]
    ds_read_b64_tr_b16 v[124:125], v234 offset:18752
    v_mfma_f32_16x16x32_bf16 v[28:31], v[188:191], v[68:71], v[28:31]
    ds_read_b128 v[68:71], v225 offset:1888
    v_mfma_f32_16x16x32_bf16 v[32:35], v[176:179], v[72:75], v[32:35]
    ds_read_b64_tr_b16 v[126:127], v234 offset:21056
    s_waitcnt lgkmcnt(11)
    s_waitcnt vmcnt(9)
    s_barrier
L_m_V12:
    s_add_u32 m0, s53, 94464
    s_add_u32 s54, s53, 294912
    buffer_load_dwordx4 v236, s[20:23], s54 offen offset:0  lds
    buffer_load_dwordx4 v236, s[20:23], s54 offen offset:1024  lds
    buffer_load_dwordx4 v236, s[20:23], s54 offen offset:2048  lds
    ds_read_b64_tr_b16 v[128:129], v234 offset:36864
    ds_read_b64_tr_b16 v[130:131], v234 offset:39168
    v_mfma_f32_16x16x32_bf16 v[36:39], v[180:183], v[72:75], v[36:39]
    ds_read_b64_tr_b16 v[132:133], v235 offset:36896
    v_mfma_f32_16x16x32_bf16 v[40:43], v[184:187], v[72:75], v[40:43]
    ds_read_b64_tr_b16 v[134:135], v235 offset:39200
    v_mfma_f32_16x16x32_bf16 v[44:47], v[188:191], v[72:75], v[44:47]
    ds_read_b128 v[72:75], v226 offset:1888
    s_waitcnt lgkmcnt(9)
    v_mfma_f32_16x16x32_bf16 v[48:51], v[176:179], v[76:79], v[48:51]
    ds_read_b64_tr_b16 v[136:137], v235 offset:37152
    v_mfma_f32_16x16x32_bf16 v[52:55], v[180:183], v[76:79], v[52:55]
    ds_read_b64_tr_b16 v[138:139], v235 offset:39456
    v_mfma_f32_16x16x32_bf16 v[56:59], v[184:187], v[76:79], v[56:59]
    ds_read_b64_tr_b16 v[140:141], v234 offset:37184
    v_mfma_f32_16x16x32_bf16 v[60:63], v[188:191], v[76:79], v[60:63]
    ds_read_b128 v[76:79], v227 offset:1888
    v_mfma_f32_16x16x32_bf16 v[0:3], v[192:195], v[64:67], v[0:3]
    ds_read_b64_tr_b16 v[142:143], v234 offset:39488
    s_waitcnt lgkmcnt(10)
    s_waitcnt vmcnt(9)
    s_barrier
L_m_V13:
    s_add_u32 m0, s53, 112896
    s_add_u32 s54, s53, 313344
    buffer_load_dwordx4 v236, s[20:23], s54 offen offset:0  lds
    buffer_load_dwordx4 v236, s[20:23], s54 offen offset:1024  lds
    buffer_load_dwordx4 v236, s[20:23], s54 offen offset:2048  lds
    ds_read_b64_tr_b16 v[144:145], v232 offset:0
    ds_read_b64_tr_b16 v[146:147], v232 offset:2304
    v_mfma_f32_16x16x32_bf16 v[4:7], v[196:199], v[64:67], v[4:7]
    ds_read_b64_tr_b16 v[148:149], v233 offset:32
    v_mfma_f32_16x16x32_bf16 v[8:11], v[200:203], v[64:67], v[8:11]
    ds_read_b64_tr_b16 v[150:151], v233 offset:2336
    v_mfma_f32_16x16x32_bf16 v[12:15], v[204:207], v[64:67], v[12:15]
    ds_read_b128 v[64:67], v224 offset:1952
    v_mfma_f32_16x16x32_bf16 v[16:19], v[192:195], v[68:71], v[16:19]
    ds_read_b64_tr_b16 v[152:153], v233 offset:288
    v_mfma_f32_16x16x32_bf16 v[20:23], v[196:199], v[68:71], v[20:23]
    ds_read_b64_tr_b16 v[154:155], v233 offset:2592
    v_mfma_f32_16x16x32_bf16 v[24:27], v[200:203], v[68:71], v[24:27]
    ds_read_b64_tr_b16 v[156:157], v232 offset:320
    v_mfma_f32_16x16x32_bf16 v[28:31], v[204:207], v[68:71], v[28:31]
    ds_read_b128 v[68:71], v225 offset:1952
    s_waitcnt lgkmcnt(9)
    v_mfma_f32_16x16x32_bf16 v[32:35], v[192:195], v[72:75], v[32:35]
    ds_read_b64_tr_b16 v[158:159], v232 offset:2624
    s_waitcnt vmcnt(9)
    s_barrier
L_m_V14:
    s_add_u32 m0, s53, 131328
    s_add_u32 s54, s53, 331776
    buffer_load_dwordx4 v236, s[20:23], s54 offen offset:0  lds
    buffer_load_dwordx4 v236, s[20:23], s54 offen offset:1024  lds
    buffer_load_dwordx4 v236, s[20:23], s54 offen offset:2048  lds
    ds_read_b64_tr_b16 v[160:161], v232 offset:18432
    ds_read_b64_tr_b16 v[162:163], v232 offset:20736
    v_mfma_f32_16x16x32_bf16 v[36:39], v[196:199], v[72:75], v[36:39]
    ds_read_b64_tr_b16 v[164:165], v233 offset:18464
    v_mfma_f32_16x16x32_bf16 v[40:43], v[200:203], v[72:75], v[40:43]
    ds_read_b64_tr_b16 v[166:167], v233 offset:20768
    v_mfma_f32_16x16x32_bf16 v[44:47], v[204:207], v[72:75], v[44:47]
    ds_read_b128 v[72:75], v226 offset:1952
    v_mfma_f32_16x16x32_bf16 v[48:51], v[192:195], v[76:79], v[48:51]
    ds_read_b64_tr_b16 v[168:169], v233 offset:18720
    v_mfma_f32_16x16x32_bf16 v[52:55], v[196:199], v[76:79], v[52:55]
    ds_read_b64_tr_b16 v[170:171], v233 offset:21024
    v_mfma_f32_16x16x32_bf16 v[56:59], v[200:203], v[76:79], v[56:59]
    ds_read_b64_tr_b16 v[172:173], v232 offset:18752
    v_mfma_f32_16x16x32_bf16 v[60:63], v[204:207], v[76:79], v[60:63]
    ds_read_b128 v[76:79], v227 offset:1952
    s_waitcnt lgkmcnt(9)
    v_mfma_f32_16x16x32_bf16 v[0:3], v[208:211], v[64:67], v[0:3]
    ds_read_b64_tr_b16 v[174:175], v232 offset:21056
    s_waitcnt vmcnt(9)
    s_barrier
L_m_V15:
    s_add_u32 m0, s53, 39168
    s_add_u32 s54, s53, 350208
    buffer_load_dwordx4 v236, s[20:23], s54 offen offset:0  lds
    buffer_load_dwordx4 v236, s[20:23], s54 offen offset:1024  lds
    buffer_load_dwordx4 v236, s[20:23], s54 offen offset:2048  lds
    ds_read_b64_tr_b16 v[176:177], v232 offset:36864
    ds_read_b64_tr_b16 v[178:179], v232 offset:39168
    v_mfma_f32_16x16x32_bf16 v[4:7], v[212:215], v[64:67], v[4:7]
    ds_read_b64_tr_b16 v[180:181], v233 offset:36896
    v_mfma_f32_16x16x32_bf16 v[8:11], v[216:219], v[64:67], v[8:11]
    ds_read_b64_tr_b16 v[182:183], v233 offset:39200
    v_mfma_f32_16x16x32_bf16 v[12:15], v[220:223], v[64:67], v[12:15]
    ds_read_b128 v[64:67], v224 offset:1152
    v_mfma_f32_16x16x32_bf16 v[16:19], v[208:211], v[68:71], v[16:19]
    ds_read_b64_tr_b16 v[184:185], v233 offset:37152
    v_mfma_f32_16x16x32_bf16 v[20:23], v[212:215], v[68:71], v[20:23]
    ds_read_b64_tr_b16 v[186:187], v233 offset:39456
    v_mfma_f32_16x16x32_bf16 v[24:27], v[216:219], v[68:71], v[24:27]
    ds_read_b64_tr_b16 v[188:189], v232 offset:37184
    v_mfma_f32_16x16x32_bf16 v[28:31], v[220:223], v[68:71], v[28:31]
    ds_read_b128 v[68:71], v225 offset:1152
    s_waitcnt lgkmcnt(9)
    v_mfma_f32_16x16x32_bf16 v[32:35], v[208:211], v[72:75], v[32:35]
    ds_read_b64_tr_b16 v[190:191], v232 offset:39488
    s_waitcnt vmcnt(9)
    s_barrier
L_m_V16:
    s_add_u32 m0, s53, 57600
    s_add_u32 s54, s53, 368640
    buffer_load_dwordx4 v236, s[20:23], s54 offen offset:0  lds
    buffer_load_dwordx4 v236, s[20:23], s54 offen offset:1024  lds
    buffer_load_dwordx4 v236, s[20:23], s54 offen offset:2048  lds
    ds_read_b64_tr_b16 v[192:193], v234 offset:0
    ds_read_b64_tr_b16 v[194:195], v234 offset:2304
    v_mfma_f32_16x16x32_bf16 v[36:39], v[212:215], v[72:75], v[36:39]
    ds_read_b64_tr_b16 v[196:197], v235 offset:32
    v_mfma_f32_16x16x32_bf16 v[40:43], v[216:219], v[72:75], v[40:43]
    ds_read_b64_tr_b16 v[198:199], v235 offset:2336
    v_mfma_f32_16x16x32_bf16 v[44:47], v[220:223], v[72:75], v[44:47]
    ds_read_b128 v[72:75], v226 offset:1152
    v_mfma_f32_16x16x32_bf16 v[48:51], v[208:211], v[76:79], v[48:51]
    ds_read_b64_tr_b16 v[200:201], v235 offset:288
    v_mfma_f32_16x16x32_bf16 v[52:55], v[212:215], v[76:79], v[52:55]
    ds_read_b64_tr_b16 v[202:203], v235 offset:2592
    v_mfma_f32_16x16x32_bf16 v[56:59], v[216:219], v[76:79], v[56:59]
    ds_read_b64_tr_b16 v[204:205], v234 offset:320
    v_mfma_f32_16x16x32_bf16 v[60:63], v[220:223], v[76:79], v[60:63]
    ds_read_b128 v[76:79], v227 offset:1152
    s_waitcnt lgkmcnt(9)
    v_mfma_f32_16x16x32_bf16 v[0:3], v[80:83], v[64:67], v[0:3]
    ds_read_b64_tr_b16 v[206:207], v234 offset:2624
    s_waitcnt vmcnt(9)
    s_barrier
L_m_V17:
    s_add_u32 m0, s53, 76032
    s_add_u32 s54, s53, 387072
    buffer_load_dwordx4 v236, s[20:23], s54 offen offset:0  lds
    buffer_load_dwordx4 v236, s[20:23], s54 offen offset:1024  lds
    buffer_load_dwordx4 v236, s[20:23], s54 offen offset:2048  lds
    ds_read_b64_tr_b16 v[208:209], v234 offset:18432
    ds_read_b64_tr_b16 v[210:211], v234 offset:20736
    v_mfma_f32_16x16x32_bf16 v[4:7], v[84:87], v[64:67], v[4:7]
    ds_read_b64_tr_b16 v[212:213], v235 offset:18464
    v_mfma_f32_16x16x32_bf16 v[8:11], v[88:91], v[64:67], v[8:11]
    ds_read_b64_tr_b16 v[214:215], v235 offset:20768
    v_mfma_f32_16x16x32_bf16 v[12:15], v[92:95], v[64:67], v[12:15]
    ds_read_b128 v[64:67], v224 offset:1216
    v_mfma_f32_16x16x32_bf16 v[16:19], v[80:83], v[68:71], v[16:19]
    ds_read_b64_tr_b16 v[216:217], v235 offset:18720
    v_mfma_f32_16x16x32_bf16 v[20:23], v[84:87], v[68:71], v[20:23]
    ds_read_b64_tr_b16 v[218:219], v235 offset:21024
    v_mfma_f32_16x16x32_bf16 v[24:27], v[88:91], v[68:71], v[24:27]
    ds_read_b64_tr_b16 v[220:221], v234 offset:18752
    v_mfma_f32_16x16x32_bf16 v[28:31], v[92:95], v[68:71], v[28:31]
    ds_read_b128 v[68:71], v225 offset:1216
    s_waitcnt lgkmcnt(9)
    v_mfma_f32_16x16x32_bf16 v[32:35], v[80:83], v[72:75], v[32:35]
    ds_read_b64_tr_b16 v[222:223], v234 offset:21056
    s_waitcnt vmcnt(9)
    s_barrier
L_m_V18:
    s_add_u32 m0, s53, 94464
    s_nop 0
    buffer_load_dwordx4 v238, s[20:23], 0 offen offset:0  lds
    buffer_load_dwordx4 v238, s[20:23], 0 offen offset:1024  lds
    buffer_load_dwordx4 v238, s[20:23], 0 offen offset:2048  lds
    s_add_u32 m0, s52, 94464
    s_nop 0
    buffer_load_dwordx4 v239, s[20:23], 0 offen offset:0  lds
    s_mov_b32 exec_hi, 0
    buffer_load_dwordx4 v239, s[20:23], 0 offen offset:1024  lds
    s_mov_b32 exec_hi, -1
    v_mfma_f32_16x16x32_bf16 v[36:39], v[84:87], v[72:75], v[36:39]
L_wp3:
    s_cbranch_execz L_wback
    v_mfma_f32_16x16x32_bf16 v[40:43], v[88:91], v[72:75], v[40:43]
    v_mfma_f32_16x16x32_bf16 v[44:47], v[92:95], v[72:75], v[44:47]
    ds_read_b128 v[72:75], v226 offset:1216
    v_mfma_f32_16x16x32_bf16 v[48:51], v[80:83], v[76:79], v[48:51]
    v_mfma_f32_16x16x32_bf16 v[52:55], v[84:87], v[76:79], v[52:55]
    v_mfma_f32_16x16x32_bf16 v[56:59], v[88:91], v[76:79], v[56:59]
    v_mfma_f32_16x16x32_bf16 v[60:63], v[92:95], v[76:79], v[60:63]
    ds_read_b128 v[76:79], v227 offset:1216
    s_waitcnt lgkmcnt(7)
    v_mfma_f32_16x16x32_bf16 v[0:3], v[96:99], v[64:67], v[0:3]
    ds_read_b64_tr_b16 v[80:81], v234 offset:36864
    s_waitcnt vmcnt(11)
    s_barrier
L_m_V19:
    ds_read_b64_tr_b16 v[82:83], v234 offset:39168
    ds_read_b64_tr_b16 v[84:85], v235 offset:36896
    v_mfma_f32_16x16x32_bf16 v[4:7], v[100:103], v[64:67], v[4:7]
    ds_read_b64_tr_b16 v[86:87], v235 offset:39200
    v_mfma_f32_16x16x32_bf16 v[8:11], v[104:107], v[64:67], v[8:11]
    ds_read_b64_tr_b16 v[88:89], v235 offset:37152
    v_mfma_f32_16x16x32_bf16 v[12:15], v[108:111], v[64:67], v[12:15]
    ds_read_b128 v[64:67], v224 offset:1280
    s_waitcnt lgkmcnt(9)
    v_mfma_f32_16x16x32_bf16 v[16:19], v[96:99], v[68:71], v[16:19]
    ds_read_b64_tr_b16 v[90:91], v235 offset:39456
    v_mfma_f32_16x16x32_bf16 v[20:23], v[100:103], v[68:71], v[20:23]
    ds_read_b64_tr_b16 v[92:93], v234 offset:37184
    v_mfma_f32_16x16x32_bf16 v[24:27], v[104:107], v[68:71], v[24:27]
    ds_read_b64_tr_b16 v[94:95], v234 offset:39488
    v_mfma_f32_16x16x32_bf16 v[28:31], v[108:111], v[68:71], v[28:31]
    ds_read_b128 v[68:71], v225 offset:1280
    s_waitcnt lgkmcnt(11)
    v_mfma_f32_16x16x32_bf16 v[32:35], v[96:99], v[72:75], v[32:35]
    v_mfma_f32_16x16x32_bf16 v[36:39], v[100:103], v[72:75], v[36:39]
    s_waitcnt lgkmcnt(1)
    s_waitcnt vmcnt(0)
    s_barrier
L_m_V20:
    s_mul_i32 s54, s39, 10368
    s_add_u32 m0, s54, 112896
    s_nop 0
    buffer_load_dwordx4 v237, s[24:27], s54 offen offset:0 lds
    buffer_load_dwordx4 v237, s[24:27], s54 offen offset:1024 lds
    buffer_load_dwordx4 v237, s[24:27], s54 offen offset:2048 lds
    buffer_load_dwordx4 v237, s[24:27], s54 offen offset:3072 lds
    s_add_u32 s54, s54, 4096
    s_add_u32 m0, s54, 112896
    s_nop 0
    buffer_load_dwordx4 v237, s[24:27], s54 offen offset:0 lds
    buffer_load_dwordx4 v237, s[24:27], s54 offen offset:1024 lds
    buffer_load_dwordx4 v237, s[24:27], s54 offen offset:2048 lds
    buffer_load_dwordx4 v237, s[24:27], s54 offen offset:3072 lds
    s_add_u32 s54, s54, 4096
    s_add_u32 m0, s54, 112896
    s_nop 0
    buffer_load_dwordx4 v237, s[24:27], s54 offen offset:0 lds
    buffer_load_dwordx4 v237, s[24:27], s54 offen offset:1024 lds
    s_mov_b64 exec, 0xff
    buffer_load_dwordx4 v237, s[24:27], s54 offen offset:2048 lds
    s_mov_b64 exec, -1
L_m_Vw:
    v_add_u32 v249, s12, v241
    v_add_u32 v238, s13, v241
    v_add_u32 v239, s14, v241
    v_add_u32 v236, s15, v241
    v_mfma_f32_16x16x32_bf16 v[40:43], v[104:107], v[72:75], v[40:43]
    v_mfma_f32_16x16x32_bf16 v[44:47], v[108:111], v[72:75], v[44:47]
    ds_read_b128 v[72:75], v226 offset:1280
    v_mfma_f32_16x16x32_bf16 v[48:51], v[96:99], v[76:79], v[48:51]
    v_mfma_f32_16x16x32_bf16 v[52:55], v[100:103], v[76:79], v[52:55]
    s_waitcnt vmcnt(0)
    s_barrier
    v_mfma_f32_16x16x32_bf16 v[56:59], v[104:107], v[76:79], v[56:59]
    v_mfma_f32_16x16x32_bf16 v[60:63], v[108:111], v[76:79], v[60:63]
    ds_read_b128 v[76:79], v227 offset:1280
    v_mfma_f32_16x16x32_bf16 v[0:3], v[112:115], v[64:67], v[0:3]
    ds_read_b64_tr_b16 v[96:97], v232 offset:0
    v_mfma_f32_16x16x32_bf16 v[4:7], v[116:119], v[64:67], v[4:7]
    ds_read_b64_tr_b16 v[98:99], v232 offset:2304
    v_mfma_f32_16x16x32_bf16 v[8:11], v[120:123], v[64:67], v[8:11]
    ds_read_b64_tr_b16 v[100:101], v233 offset:32
    v_mfma_f32_16x16x32_bf16 v[12:15], v[124:127], v[64:67], v[12:15]
    ds_read_b128 v[64:67], v224 offset:1344
    s_waitcnt lgkmcnt(6)
    v_mfma_f32_16x16x32_bf16 v[16:19], v[112:115], v[68:71], v[16:19]
    ds_read_b64_tr_b16 v[102:103], v233 offset:2336
    v_mfma_f32_16x16x32_bf16 v[20:23], v[116:119], v[68:71], v[20:23]
    ds_read_b64_tr_b16 v[104:105], v233 offset:288
    v_mfma_f32_16x16x32_bf16 v[24:27], v[120:123], v[68:71], v[24:27]
    ds_read_b64_tr_b16 v[106:107], v233 offset:2592
    v_mfma_f32_16x16x32_bf16 v[28:31], v[124:127], v[68:71], v[28:31]
    ds_read_b128 v[68:71], v225 offset:1344
    s_waitcnt lgkmcnt(9)
    v_mfma_f32_16x16x32_bf16 v[32:35], v[112:115], v[72:75], v[32:35]
    ds_read_b64_tr_b16 v[108:109], v232 offset:320
    v_mfma_f32_16x16x32_bf16 v[36:39], v[116:119], v[72:75], v[36:39]
    ds_read_b64_tr_b16 v[110:111], v232 offset:2624
    v_mfma_f32_16x16x32_bf16 v[40:43], v[120:123], v[72:75], v[40:43]
    v_mfma_f32_16x16x32_bf16 v[44:47], v[124:127], v[72:75], v[44:47]
    ds_read_b128 v[72:75], v226 offset:1344
    s_waitcnt lgkmcnt(11)
    v_mfma_f32_16x16x32_bf16 v[48:51], v[112:115], v[76:79], v[48:51]
    v_mfma_f32_16x16x32_bf16 v[52:55], v[116:119], v[76:79], v[52:55]
    v_mfma_f32_16x16x32_bf16 v[56:59], v[120:123], v[76:79], v[56:59]
    v_mfma_f32_16x16x32_bf16 v[60:63], v[124:127], v[76:79], v[60:63]
    ds_read_b128 v[76:79], v227 offset:1344
    s_waitcnt lgkmcnt(8)
    v_mfma_f32_16x16x32_bf16 v[0:3], v[128:131], v[64:67], v[0:3]
    ds_read_b64_tr_b16 v[112:113], v232 offset:18432
    v_mfma_f32_16x16x32_bf16 v[4:7], v[132:135], v[64:67], v[4:7]
    ds_read_b64_tr_b16 v[114:115], v232 offset:20736
    v_mfma_f32_16x16x32_bf16 v[8:11], v[136:139], v[64:67], v[8:11]
    ds_read_b64_tr_b16 v[116:117], v233 offset:18464
    v_mfma_f32_16x16x32_bf16 v[12:15], v[140:143], v[64:67], v[12:15]
    ds_read_b128 v[64:67], v228 offset:576
    s_waitcnt lgkmcnt(8)
    v_mfma_f32_16x16x32_bf16 v[16:19], v[128:131], v[68:71], v[16:19]
    ds_read_b64_tr_b16 v[118:119], v233 offset:20768
    v_mfma_f32_16x16x32_bf16 v[20:23], v[132:135], v[68:71], v[20:23]
    ds_read_b64_tr_b16 v[120:121], v233 offset:18720
    v_mfma_f32_16x16x32_bf16 v[24:27], v[136:139], v[68:71], v[24:27]
    ds_read_b64_tr_b16 v[122:123], v233 offset:21024
    v_mfma_f32_16x16x32_bf16 v[28:31], v[140:143], v[68:71], v[28:31]
    ds_read_b128 v[68:71], v229 offset:576
    s_waitcnt lgkmcnt(9)
    v_mfma_f32_16x16x32_bf16 v[32:35], v[128:131], v[72:75], v[32:35]
    ds_read_b64_tr_b16 v[124:125], v232 offset:18752
    v_mfma_f32_16x16x32_bf16 v[36:39], v[132:135], v[72:75], v[36:39]
    ds_read_b64_tr_b16 v[126:127], v232 offset:21056
    v_mfma_f32_16x16x32_bf16 v[40:43], v[136:139], v[72:75], v[40:43]
    v_mfma_f32_16x16x32_bf16 v[44:47], v[140:143], v[72:75], v[44:47]
    ds_read_b128 v[72:75], v230 offset:576
    s_waitcnt lgkmcnt(11)
    v_mfma_f32_16x16x32_bf16 v[48:51], v[128:131], v[76:79], v[48:51]
    v_mfma_f32_16x16x32_bf16 v[52:55], v[132:135], v[76:79], v[52:55]
    v_mfma_f32_16x16x32_bf16 v[56:59], v[136:139], v[76:79], v[56:59]
    v_mfma_f32_16x16x32_bf16 v[60:63], v[140:143], v[76:79], v[60:63]
    ds_read_b128 v[76:79], v231 offset:576
    s_waitcnt lgkmcnt(8)
    v_mfma_f32_16x16x32_bf16 v[0:3], v[144:147], v[64:67], v[0:3]
    ds_read_b64_tr_b16 v[128:129], v232 offset:36864
    v_mfma_f32_16x16x32_bf16 v[4:7], v[148:151], v[64:67], v[4:7]
    ds_read_b64_tr_b16 v[130:131], v232 offset:39168
    v_mfma_f32_16x16x32_bf16 v[8:11], v[152:155], v[64:67], v[8:11]
    ds_read_b64_tr_b16 v[132:133], v233 offset:36896
    v_mfma_f32_16x16x32_bf16 v[12:15], v[156:159], v[64:67], v[12:15]
    ds_read_b128 v[64:67], v224 offset:608
    s_waitcnt lgkmcnt(8)
    v_mfma_f32_16x16x32_bf16 v[16:19], v[144:147], v[68:71], v[16:19]
    ds_read_b64_tr_b16 v[134:135], v233 offset:39200
    v_mfma_f32_16x16x32_bf16 v[20:23], v[148:151], v[68:71], v[20:23]
    ds_read_b64_tr_b16 v[136:137], v233 offset:37152
    v_mfma_f32_16x16x32_bf16 v[24:27], v[152:155], v[68:71], v[24:27]
    ds_read_b64_tr_b16 v[138:139], v233 offset:39456
    v_mfma_f32_16x16x32_bf16 v[28:31], v[156:159], v[68:71], v[28:31]
    ds_read_b128 v[68:71], v225 offset:608
    s_waitcnt lgkmcnt(9)
    v_mfma_f32_16x16x32_bf16 v[32:35], v[144:147], v[72:75], v[32:35]
    ds_read_b64_tr_b16 v[140:141], v232 offset:37184
    v_mfma_f32_16x16x32_bf16 v[36:39], v[148:151], v[72:75], v[36:39]
    ds_read_b64_tr_b16 v[142:143], v232 offset:39488
    v_mfma_f32_16x16x32_bf16 v[40:43], v[152:155], v[72:75], v[40:43]
    v_mfma_f32_16x16x32_bf16 v[44:47], v[156:159], v[72:75], v[44:47]
    ds_read_b128 v[72:75], v226 offset:608
    s_waitcnt lgkmcnt(11)
    v_mfma_f32_16x16x32_bf16 v[48:51], v[144:147], v[76:79], v[48:51]
    v_mfma_f32_16x16x32_bf16 v[52:55], v[148:151], v[76:79], v[52:55]
    v_mfma_f32_16x16x32_bf16 v[56:59], v[152:155], v[76:79], v[56:59]
    v_mfma_f32_16x16x32_bf16 v[60:63], v[156:159], v[76:79], v[60:63]
    ds_read_b128 v[76:79], v227 offset:608
    s_waitcnt lgkmcnt(8)
    v_mfma_f32_16x16x32_bf16 v[0:3], v[160:163], v[64:67], v[0:3]
    ds_read_b64_tr_b16 v[144:145], v234 offset:0
    v_mfma_f32_16x16x32_bf16 v[4:7], v[164:167], v[64:67], v[4:7]
    ds_read_b64_tr_b16 v[146:147], v234 offset:2304
    v_mfma_f32_16x16x32_bf16 v[8:11], v[168:171], v[64:67], v[8:11]
    ds_read_b64_tr_b16 v[148:149], v235 offset:32
    v_mfma_f32_16x16x32_bf16 v[12:15], v[172:175], v[64:67], v[12:15]
    ds_read_b128 v[64:67], v224 offset:672
    s_waitcnt lgkmcnt(8)
    v_mfma_f32_16x16x32_bf16 v[16:19], v[160:163], v[68:71], v[16:19]
    ds_read_b64_tr_b16 v[150:151], v235 offset:2336
    v_mfma_f32_16x16x32_bf16 v[20:23], v[164:167], v[68:71], v[20:23]
    ds_read_b64_tr_b16 v[152:153], v235 offset:288
    v_mfma_f32_16x16x32_bf16 v[24:27], v[168:171], v[68:71], v[24:27]
    ds_read_b64_tr_b16 v[154:155], v235 offset:2592
    v_mfma_f32_16x16x32_bf16 v[28:31], v[172:175], v[68:71], v[28:31]
    ds_read_b128 v[68:71], v225 offset:672
    s_waitcnt lgkmcnt(9)
    v_mfma_f32_16x16x32_bf16 v[32:35], v[160:163], v[72:75], v[32:35]
    ds_read_b64_tr_b16 v[156:157], v234 offset:320
    v_mfma_f32_16x16x32_bf16 v[36:39], v[164:167], v[72:75], v[36:39]
    ds_read_b64_tr_b16 v[158:159], v234 offset:2624
    v_mfma_f32_16x16x32_bf16 v[40:43], v[168:171], v[72:75], v[40:43]
    v_mfma_f32_16x16x32_bf16 v[44:47], v[172:175], v[72:75], v[44:47]
    ds_read_b128 v[72:75], v226 offset:672
    s_waitcnt lgkmcnt(11)
    v_mfma_f32_16x16x32_bf16 v[48:51], v[160:163], v[76:79], v[48:51]
    v_mfma_f32_16x16x32_bf16 v[52:55], v[164:167], v[76:79], v[52:55]
    v_mfma_f32_16x16x32_bf16 v[56:59], v[168:171], v[76:79], v[56:59]
    v_mfma_f32_16x16x32_bf16 v[60:63], v[172:175], v[76:79], v[60:63]
    ds_read_b128 v[76:79], v227 offset:672
    s_waitcnt lgkmcnt(8)
    v_mfma_f32_16x16x32_bf16 v[0:3], v[176:179], v[64:67], v[0:3]
    ds_read_b64_tr_b16 v[160:161], v241 offset:36864
    v_mfma_f32_16x16x32_bf16 v[4:7], v[180:183], v[64:67], v[4:7]
    ds_read_b64_tr_b16 v[162:163], v241 offset:36896
    v_mfma_f32_16x16x32_bf16 v[8:11], v[184:187], v[64:67], v[8:11]
    ds_read_b64_tr_b16 v[164:165], v241 offset:36928
    v_mfma_f32_16x16x32_bf16 v[12:15], v[188:191], v[64:67], v[12:15]
    ds_read_b128 v[64:67], v224 offset:736
    s_waitcnt lgkmcnt(8)
    v_mfma_f32_16x16x32_bf16 v[16:19], v[176:179], v[68:71], v[16:19]
    ds_read_b64_tr_b16 v[166:167], v241 offset:36960
    v_mfma_f32_16x16x32_bf16 v[20:23], v[180:183], v[68:71], v[20:23]
    ds_read_b64_tr_b16 v[168:169], v241 offset:36992
    v_mfma_f32_16x16x32_bf16 v[24:27], v[184:187], v[68:71], v[24:27]
    ds_read_b64_tr_b16 v[170:171], v241 offset:37024
    v_mfma_f32_16x16x32_bf16 v[28:31], v[188:191], v[68:71], v[28:31]
    ds_read_b128 v[68:71], v225 offset:736
    s_waitcnt lgkmcnt(9)
    v_mfma_f32_16x16x32_bf16 v[32:35], v[176:179], v[72:75], v[32:35]
    ds_read_b64_tr_b16 v[172:173], v241 offset:37056
    v_mfma_f32_16x16x32_bf16 v[36:39], v[180:183], v[72:75], v[36:39]
    ds_read_b64_tr_b16 v[174:175], v241 offset:37088
    v_mfma_f32_16x16x32_bf16 v[40:43], v[184:187], v[72:75], v[40:43]
    v_mfma_f32_16x16x32_bf16 v[44:47], v[188:191], v[72:75], v[44:47]
    ds_read_b128 v[72:75], v226 offset:736
    s_waitcnt lgkmcnt(11)
    v_mfma_f32_16x16x32_bf16 v[48:51], v[176:179], v[76:79], v[48:51]
    v_mfma_f32_16x16x32_bf16 v[52:55], v[180:183], v[76:79], v[52:55]
    v_mfma_f32_16x16x32_bf16 v[56:59], v[184:187], v[76:79], v[56:59]
    v_mfma_f32_16x16x32_bf16 v[60:63], v[188:191], v[76:79], v[60:63]
    ds_read_b128 v[76:79], v227 offset:736
    s_waitcnt lgkmcnt(8)
    v_mfma_f32_16x16x32_bf16 v[0:3], v[192:195], v[64:67], v[0:3]
    ds_read_b64_tr_b16 v[176:177], v241 offset:37120
    v_mfma_f32_16x16x32_bf16 v[4:7], v[196:199], v[64:67], v[4:7]
    ds_read_b64_tr_b16 v[180:181], v238 offset:0
    v_mfma_f32_16x16x32_bf16 v[8:11], v[200:203], v[64:67], v[8:11]
    ds_read_b64_tr_b16 v[182:183], v238 offset:4608
    v_mfma_f32_16x16x32_bf16 v[12:15], v[204:207], v[64:67], v[12:15]
    ds_read_b128 v[64:67], v224 offset:800
    s_waitcnt lgkmcnt(8)
    v_mfma_f32_16x16x32_bf16 v[16:19], v[192:195], v[68:71], v[16:19]
    ds_read_b64_tr_b16 v[184:185], v238 offset:32
    v_mfma_f32_16x16x32_bf16 v[20:23], v[196:199], v[68:71], v[20:23]
    ds_read_b64_tr_b16 v[186:187], v238 offset:4640
    v_mfma_f32_16x16x32_bf16 v[24:27], v[200:203], v[68:71], v[24:27]
    ds_read_b64_tr_b16 v[188:189], v238 offset:64
    v_mfma_f32_16x16x32_bf16 v[28:31], v[204:207], v[68:71], v[28:31]
    ds_read_b128 v[68:71], v225 offset:800
    s_waitcnt lgkmcnt(9)
    v_mfma_f32_16x16x32_bf16 v[32:35], v[192:195], v[72:75], v[32:35]
    ds_read_b64_tr_b16 v[190:191], v238 offset:4672
    v_mfma_f32_16x16x32_bf16 v[36:39], v[196:199], v[72:75], v[36:39]
    v_mfma_f32_16x16x32_bf16 v[40:43], v[200:203], v[72:75], v[40:43]
    v_mfma_f32_16x16x32_bf16 v[44:47], v[204:207], v[72:75], v[44:47]
    ds_read_b128 v[72:75], v226 offset:800
    s_waitcnt lgkmcnt(10)
    v_mfma_f32_16x16x32_bf16 v[48:51], v[192:195], v[76:79], v[48:51]
    v_mfma_f32_16x16x32_bf16 v[52:55], v[196:199], v[76:79], v[52:55]
    v_mfma_f32_16x16x32_bf16 v[56:59], v[200:203], v[76:79], v[56:59]
    v_mfma_f32_16x16x32_bf16 v[60:63], v[204:207], v[76:79], v[60:63]
    ds_read_b128 v[76:79], v227 offset:800
    s_waitcnt lgkmcnt(7)
    v_mfma_f32_16x16x32_bf16 v[0:3], v[208:211], v[64:67], v[0:3]
    ds_read_b64_tr_b16 v[192:193], v238 offset:96
    v_mfma_f32_16x16x32_bf16 v[4:7], v[212:215], v[64:67], v[4:7]
    ds_read_b64_tr_b16 v[194:195], v238 offset:4704
    v_mfma_f32_16x16x32_bf16 v[8:11], v[216:219], v[64:67], v[8:11]
    ds_read_b64_tr_b16 v[196:197], v238 offset:128
    v_mfma_f32_16x16x32_bf16 v[12:15], v[220:223], v[64:67], v[12:15]
    ds_read_b128 v[64:67], v224 offset:0
    s_waitcnt lgkmcnt(7)
    v_mfma_f32_16x16x32_bf16 v[16:19], v[208:211], v[68:71], v[16:19]
    ds_read_b64_tr_b16 v[198:199], v238 offset:4736
    v_mfma_f32_16x16x32_bf16 v[20:23], v[212:215], v[68:71], v[20:23]
    ds_read_b64_tr_b16 v[200:201], v238 offset:160
    v_mfma_f32_16x16x32_bf16 v[24:27], v[216:219], v[68:71], v[24:27]
    ds_read_b64_tr_b16 v[202:203], v238 offset:4768
    v_mfma_f32_16x16x32_bf16 v[28:31], v[220:223], v[68:71], v[28:31]
    ds_read_b128 v[68:71], v225 offset:0
    s_waitcnt lgkmcnt(9)
    v_mfma_f32_16x16x32_bf16 v[32:35], v[208:211], v[72:75], v[32:35]
    ds_read_b64_tr_b16 v[204:205], v238 offset:192
    v_mfma_f32_16x16x32_bf16 v[36:39], v[212:215], v[72:75], v[36:39]
    ds_read_b64_tr_b16 v[206:207], v238 offset:4800
    v_mfma_f32_16x16x32_bf16 v[40:43], v[216:219], v[72:75], v[40:43]
    v_mfma_f32_16x16x32_bf16 v[44:47], v[220:223], v[72:75], v[44:47]
    ds_read_b128 v[72:75], v226 offset:0
    s_waitcnt lgkmcnt(11)
    v_mfma_f32_16x16x32_bf16 v[48:51], v[208:211], v[76:79], v[48:51]
    v_mfma_f32_16x16x32_bf16 v[52:55], v[212:215], v[76:79], v[52:55]
    v_mfma_f32_16x16x32_bf16 v[56:59], v[216:219], v[76:79], v[56:59]
    v_mfma_f32_16x16x32_bf16 v[60:63], v[220:223], v[76:79], v[60:63]
    ds_read_b128 v[76:79], v227 offset:0
    s_waitcnt lgkmcnt(8)
    v_mfma_f32_16x16x32_bf16 v[0:3], v[80:83], v[64:67], v[0:3]
    ds_read_b64_tr_b16 v[208:209], v238 offset:224
    v_mfma_f32_16x16x32_bf16 v[4:7], v[84:87], v[64:67], v[4:7]
    ds_read_b64_tr_b16 v[210:211], v238 offset:4832
    v_mfma_f32_16x16x32_bf16 v[8:11], v[88:91], v[64:67], v[8:11]
    ds_read_b64_tr_b16 v[212:213], v238 offset:256
    v_mfma_f32_16x16x32_bf16 v[12:15], v[92:95], v[64:67], v[12:15]
    ds_read_b128 v[64:67], v224 offset:64
    s_waitcnt lgkmcnt(8)
    v_mfma_f32_16x16x32_bf16 v[16:19], v[80:83], v[68:71], v[16:19]
    ds_read_b64_tr_b16 v[214:215], v238 offset:4864
    v_mfma_f32_16x16x32_bf16 v[20:23], v[84:87], v[68:71], v[20:23]
    ds_read_b64_tr_b16 v[216:217], v239 offset:0
    v_mfma_f32_16x16x32_bf16 v[24:27], v[88:91], v[68:71], v[24:27]
    ds_read_b64_tr_b16 v[218:219], v239 offset:4608
    v_mfma_f32_16x16x32_bf16 v[28:31], v[92:95], v[68:71], v[28:31]
    ds_read_b128 v[68:71], v225 offset:64
    s_waitcnt lgkmcnt(9)
    v_mfma_f32_16x16x32_bf16 v[32:35], v[80:83], v[72:75], v[32:35]
    ds_read_b64_tr_b16 v[220:221], v236 offset:0
    v_mfma_f32_16x16x32_bf16 v[36:39], v[84:87], v[72:75], v[36:39]
    ds_read_b64_tr_b16 v[222:223], v236 offset:4608
    v_mfma_f32_16x16x32_bf16 v[40:43], v[88:91], v[72:75], v[40:43]
    v_mfma_f32_16x16x32_bf16 v[44:47], v[92:95], v[72:75], v[44:47]
    ds_read_b128 v[72:75], v226 offset:64
    s_waitcnt lgkmcnt(11)
    v_mfma_f32_16x16x32_bf16 v[48:51], v[80:83], v[76:79], v[48:51]
    v_mfma_f32_16x16x32_bf16 v[52:55], v[84:87], v[76:79], v[52:55]
    v_mfma_f32_16x16x32_bf16 v[56:59], v[88:91], v[76:79], v[56:59]
    v_mfma_f32_16x16x32_bf16 v[60:63], v[92:95], v[76:79], v[60:63]
    ds_read_b128 v[76:79], v227 offset:64
    s_waitcnt lgkmcnt(8)
    v_mfma_f32_16x16x32_bf16 v[0:3], v[96:99], v[64:67], v[0:3]
    ds_read_b64_tr_b16 v[80:81], v249 offset:0
    v_mfma_f32_16x16x32_bf16 v[4:7], v[100:103], v[64:67], v[4:7]
    ds_read_b64_tr_b16 v[82:83], v249 offset:4608
    v_mfma_f32_16x16x32_bf16 v[8:11], v[104:107], v[64:67], v[8:11]
    ds_read_b64_tr_b16 v[84:85], v239 offset:32
    v_mfma_f32_16x16x32_bf16 v[12:15], v[108:111], v[64:67], v[12:15]
    ds_read_b128 v[64:67], v224 offset:128
    s_waitcnt lgkmcnt(8)
    v_mfma_f32_16x16x32_bf16 v[16:19], v[96:99], v[68:71], v[16:19]
    ds_read_b64_tr_b16 v[86:87], v239 offset:4640
    v_mfma_f32_16x16x32_bf16 v[20:23], v[100:103], v[68:71], v[20:23]
    ds_read_b64_tr_b16 v[88:89], v236 offset:32
    v_mfma_f32_16x16x32_bf16 v[24:27], v[104:107], v[68:71], v[24:27]
    ds_read_b64_tr_b16 v[90:91], v236 offset:4640
    v_mfma_f32_16x16x32_bf16 v[28:31], v[108:111], v[68:71], v[28:31]
    ds_read_b128 v[68:71], v225 offset:128
    s_waitcnt lgkmcnt(9)
    v_mfma_f32_16x16x32_bf16 v[32:35], v[96:99], v[72:75], v[32:35]
    ds_read_b64_tr_b16 v[92:93], v249 offset:32
    v_mfma_f32_16x16x32_bf16 v[36:39], v[100:103], v[72:75], v[36:39]
    ds_read_b64_tr_b16 v[94:95], v249 offset:4640
    v_mfma_f32_16x16x32_bf16 v[40:43], v[104:107], v[72:75], v[40:43]
    v_mfma_f32_16x16x32_bf16 v[44:47], v[108:111], v[72:75], v[44:47]
    ds_read_b128 v[72:75], v226 offset:128
    s_waitcnt lgkmcnt(11)
    v_mfma_f32_16x16x32_bf16 v[48:51], v[96:99], v[76:79], v[48:51]
    v_mfma_f32_16x16x32_bf16 v[52:55], v[100:103], v[76:79], v[52:55]
    v_mfma_f32_16x16x32_bf16 v[56:59], v[104:107], v[76:79], v[56:59]
    v_mfma_f32_16x16x32_bf16 v[60:63], v[108:111], v[76:79], v[60:63]
    ds_read_b128 v[76:79], v227 offset:128
    s_waitcnt lgkmcnt(8)
    v_mfma_f32_16x16x32_bf16 v[0:3], v[112:115], v[64:67], v[0:3]
    ds_read_b64_tr_b16 v[96:97], v239 offset:64
    v_mfma_f32_16x16x32_bf16 v[4:7], v[116:119], v[64:67], v[4:7]
    ds_read_b64_tr_b16 v[98:99], v239 offset:4672
    v_mfma_f32_16x16x32_bf16 v[8:11], v[120:123], v[64:67], v[8:11]
    ds_read_b64_tr_b16 v[100:101], v236 offset:64
    v_mfma_f32_16x16x32_bf16 v[12:15], v[124:127], v[64:67], v[12:15]
    ds_read_b128 v[64:67], v224 offset:192
    s_waitcnt lgkmcnt(8)
    v_mfma_f32_16x16x32_bf16 v[16:19], v[112:115], v[68:71], v[16:19]
    ds_read_b64_tr_b16 v[102:103], v236 offset:4672
    v_mfma_f32_16x16x32_bf16 v[20:23], v[116:119], v[68:71], v[20:23]
    ds_read_b64_tr_b16 v[104:105], v249 offset:64
    v_mfma_f32_16x16x32_bf16 v[24:27], v[120:123], v[68:71], v[24:27]
    ds_read_b64_tr_b16 v[106:107], v249 offset:4672
    v_mfma_f32_16x16x32_bf16 v[28:31], v[124:127], v[68:71], v[28:31]
    ds_read_b128 v[68:71], v225 offset:192
    s_waitcnt lgkmcnt(9)
    v_mfma_f32_16x16x32_bf16 v[32:35], v[112:115], v[72:75], v[32:35]
    ds_read_b64_tr_b16 v[108:109], v239 offset:96
    v_mfma_f32_16x16x32_bf16 v[36:39], v[116:119], v[72:75], v[36:39]
    ds_read_b64_tr_b16 v[110:111], v239 offset:4704
    v_mfma_f32_16x16x32_bf16 v[40:43], v[120:123], v[72:75], v[40:43]
    v_mfma_f32_16x16x32_bf16 v[44:47], v[124:127], v[72:75], v[44:47]
    ds_read_b128 v[72:75], v226 offset:192
    s_waitcnt lgkmcnt(11)
    v_mfma_f32_16x16x32_bf16 v[48:51], v[112:115], v[76:79], v[48:51]
    v_mfma_f32_16x16x32_bf16 v[52:55], v[116:119], v[76:79], v[52:55]
    v_mfma_f32_16x16x32_bf16 v[56:59], v[120:123], v[76:79], v[56:59]
    v_mfma_f32_16x16x32_bf16 v[60:63], v[124:127], v[76:79], v[60:63]
    ds_read_b128 v[76:79], v227 offset:192
    s_waitcnt lgkmcnt(8)
    v_mfma_f32_16x16x32_bf16 v[0:3], v[128:131], v[64:67], v[0:3]
    ds_read_b64_tr_b16 v[112:113], v236 offset:96
    v_mfma_f32_16x16x32_bf16 v[4:7], v[132:135], v[64:67], v[4:7]
    ds_read_b64_tr_b16 v[114:115], v236 offset:4704
    v_mfma_f32_16x16x32_bf16 v[8:11], v[136:139], v[64:67], v[8:11]
    ds_read_b64_tr_b16 v[116:117], v249 offset:96
    v_mfma_f32_16x16x32_bf16 v[12:15], v[140:143], v[64:67], v[12:15]
    ds_read_b128 v[64:67], v224 offset:256
    s_waitcnt lgkmcnt(8)
    v_mfma_f32_16x16x32_bf16 v[16:19], v[128:131], v[68:71], v[16:19]
    ds_read_b64_tr_b16 v[118:119], v249 offset:4704
    v_mfma_f32_16x16x32_bf16 v[20:23], v[132:135], v[68:71], v[20:23]
    ds_read_b64_tr_b16 v[120:121], v239 offset:128
    v_mfma_f32_16x16x32_bf16 v[24:27], v[136:139], v[68:71], v[24:27]
    ds_read_b64_tr_b16 v[122:123], v239 offset:4736
    v_mfma_f32_16x16x32_bf16 v[28:31], v[140:143], v[68:71], v[28:31]
    ds_read_b128 v[68:71], v225 offset:256
    s_waitcnt lgkmcnt(9)
    v_mfma_f32_16x16x32_bf16 v[32:35], v[128:131], v[72:75], v[32:35]
    ds_read_b64_tr_b16 v[124:125], v236 offset:128
    v_mfma_f32_16x16x32_bf16 v[36:39], v[132:135], v[72:75], v[36:39]
    ds_read_b64_tr_b16 v[126:127], v236 offset:4736
    v_mfma_f32_16x16x32_bf16 v[40:43], v[136:139], v[72:75], v[40:43]
    v_mfma_f32_16x16x32_bf16 v[44:47], v[140:143], v[72:75], v[44:47]
    ds_read_b128 v[72:75], v226 offset:256
    s_waitcnt lgkmcnt(11)
    v_mfma_f32_16x16x32_bf16 v[48:51], v[128:131], v[76:79], v[48:51]
    v_mfma_f32_16x16x32_bf16 v[52:55], v[132:135], v[76:79], v[52:55]
    v_mfma_f32_16x16x32_bf16 v[56:59], v[136:139], v[76:79], v[56:59]
    v_mfma_f32_16x16x32_bf16 v[60:63], v[140:143], v[76:79], v[60:63]
    ds_read_b128 v[76:79], v227 offset:256
    s_waitcnt lgkmcnt(8)
    v_mfma_f32_16x16x32_bf16 v[0:3], v[144:147], v[64:67], v[0:3]
    ds_read_b64_tr_b16 v[128:129], v249 offset:128
    v_mfma_f32_16x16x32_bf16 v[4:7], v[148:151], v[64:67], v[4:7]
    ds_read_b64_tr_b16 v[130:131], v249 offset:4736
    v_mfma_f32_16x16x32_bf16 v[8:11], v[152:155], v[64:67], v[8:11]
    ds_read_b64_tr_b16 v[132:133], v239 offset:160
    v_mfma_f32_16x16x32_bf16 v[12:15], v[156:159], v[64:67], v[12:15]
    ds_read_b64_tr_b16 v[134:135], v239 offset:4768
    s_waitcnt lgkmcnt(8)
    v_mfma_f32_16x16x32_bf16 v[16:19], v[144:147], v[68:71], v[16:19]
    ds_read_b64_tr_b16 v[136:137], v236 offset:160
    v_mfma_f32_16x16x32_bf16 v[20:23], v[148:151], v[68:71], v[20:23]
    ds_read_b64_tr_b16 v[138:139], v236 offset:4768
    v_mfma_f32_16x16x32_bf16 v[24:27], v[152:155], v[68:71], v[24:27]
    ds_read_b64_tr_b16 v[140:141], v249 offset:160
    v_mfma_f32_16x16x32_bf16 v[28:31], v[156:159], v[68:71], v[28:31]
    ds_read_b64_tr_b16 v[142:143], v249 offset:4768
    s_waitcnt lgkmcnt(9)
    v_mfma_f32_16x16x32_bf16 v[32:35], v[144:147], v[72:75], v[32:35]
    v_mfma_f32_16x16x32_bf16 v[36:39], v[148:151], v[72:75], v[36:39]
    v_mfma_f32_16x16x32_bf16 v[40:43], v[152:155], v[72:75], v[40:43]
    v_mfma_f32_16x16x32_bf16 v[44:47], v[156:159], v[72:75], v[44:47]
    s_waitcnt lgkmcnt(8)
    v_mfma_f32_16x16x32_bf16 v[48:51], v[144:147], v[76:79], v[48:51]
    v_mfma_f32_16x16x32_bf16 v[52:55], v[148:151], v[76:79], v[52:55]
    v_mfma_f32_16x16x32_bf16 v[56:59], v[152:155], v[76:79], v[56:59]
    v_mfma_f32_16x16x32_bf16 v[60:63], v[156:159], v[76:79], v[60:63]
    s_nop 3
    v_lshl_add_u32 v224, v240, 3, s58
    v_max3_f32 v228, |v0|, |v1|, |v2|
    v_max3_f32 v229, |v3|, |v4|, |v5|
    v_max3_f32 v228, v228, |v6|, |v7|
    v_max3_f32 v229, v229, |v16|, |v17|
    v_max3_f32 v228, v228, |v18|, |v19|
    v_max3_f32 v229, v229, |v20|, |v21|
    v_max3_f32 v228, v228, |v22|, |v23|
    v_max3_f32 v229, v229, |v32|, |v33|
    v_max3_f32 v228, v228, |v34|, |v35|
    v_max3_f32 v229, v229, |v36|, |v37|
    v_max3_f32 v228, v228, |v38|, |v39|
    v_max3_f32 v229, v229, |v48|, |v49|
    v_max3_f32 v228, v228, |v50|, |v51|
    v_max3_f32 v229, v229, |v52|, |v53|
    v_max3_f32 v228, v228, |v54|, |v55|
    v_max_f32 v228, v228, v229
    v_cmp_lt_f32 vcc, s44, v228
    s_cbranch_vccnz L_clampV
L_clampedV:
L_m_Va:
    s_barrier
    v_mul_f32 v16, s40, v16
    v_mul_f32 v24, s42, v24
    v_mul_f32 v17, s40, v17
    v_mul_f32 v25, s42, v25
    v_mul_f32 v18, s40, v18
    v_mul_f32 v26, s42, v26
    v_mul_f32 v19, s40, v19
    v_mul_f32 v27, s42, v27
    v_mul_f32 v20, s40, v20
    v_mul_f32 v28, s42, v28
    v_mul_f32 v21, s40, v21
    v_mul_f32 v29, s42, v29
    v_mul_f32 v22, s40, v22
    v_mul_f32 v30, s42, v30
    v_mul_f32 v23, s40, v23
    v_mul_f32 v31, s42, v31
    v_exp_f32 v24, v24
    v_exp_f32 v25, v25
    v_exp_f32 v26, v26
    v_exp_f32 v27, v27
    v_exp_f32 v28, v28
    v_exp_f32 v29, v29
    v_exp_f32 v30, v30
    v_exp_f32 v31, v31
    v_exp_f32 v16, v16
    v_exp_f32 v17, v17
    v_exp_f32 v18, v18
    v_exp_f32 v19, v19
    v_exp_f32 v20, v20
    v_exp_f32 v21, v21
    v_exp_f32 v22, v22
    v_exp_f32 v23, v23
    v_add_f32 v24, 1.0, v24
    v_add_f32 v25, 1.0, v25
    v_add_f32 v26, 1.0, v26
    v_add_f32 v27, 1.0, v27
    v_add_f32 v28, 1.0, v28
    v_add_f32 v29, 1.0, v29
    v_add_f32 v30, 1.0, v30
    v_add_f32 v31, 1.0, v31
    v_fma_f32 v24, v16, v24, v24
    v_fma_f32 v25, v17, v25, v25
    v_fma_f32 v26, v18, v26, v26
    v_fma_f32 v27, v19, v27, v27
    v_fma_f32 v28, v20, v28, v28
    v_fma_f32 v29, v21, v29, v29
    v_fma_f32 v30, v22, v30, v30
    v_fma_f32 v31, v23, v31, v31
    v_rcp_f32 v24, v24
    v_rcp_f32 v25, v25
    v_rcp_f32 v26, v26
    v_rcp_f32 v27, v27
    v_rcp_f32 v28, v28
    v_rcp_f32 v29, v29
    v_rcp_f32 v30, v30
    v_rcp_f32 v31, v31
    v_fma_f32 v16, v16, v24, -v24
    v_fma_f32 v17, v17, v25, -v25
    v_fma_f32 v18, v18, v26, -v26
    v_fma_f32 v19, v19, v27, -v27
    v_fma_f32 v20, v20, v28, -v28
    v_fma_f32 v21, v21, v29, -v29
    v_fma_f32 v22, v22, v30, -v30
    v_fma_f32 v23, v23, v31, -v31
    v_cvt_pk_bf16_f32 v68, v16, v17
    v_cvt_pk_bf16_f32 v69, v18, v19
    v_cvt_pk_bf16_f32 v70, v20, v21
    v_cvt_pk_bf16_f32 v71, v22, v23
    ds_write_b128 v250, v[68:71] offset:3072
    v_mul_f32 v32, s40, v32
    v_mul_f32 v40, s42, v40
    v_mul_f32 v33, s40, v33
    v_mul_f32 v41, s42, v41
    v_mul_f32 v34, s40, v34
    v_mul_f32 v42, s42, v42
    v_mul_f32 v35, s40, v35
    v_mul_f32 v43, s42, v43
    v_mul_f32 v36, s40, v36
    v_mul_f32 v44, s42, v44
    v_mul_f32 v37, s40, v37
    v_mul_f32 v45, s42, v45
    v_mul_f32 v38, s40, v38
    v_mul_f32 v46, s42, v46
    v_mul_f32 v39, s40, v39
    v_mul_f32 v47, s42, v47
    v_exp_f32 v40, v40
    v_exp_f32 v41, v41
    v_exp_f32 v42, v42
    v_exp_f32 v43, v43
    v_exp_f32 v44, v44
    v_exp_f32 v45, v45
    v_exp_f32 v46, v46
    v_exp_f32 v47, v47
    v_exp_f32 v32, v32
    v_exp_f32 v33, v33
    v_exp_f32 v34, v34
    v_exp_f32 v35, v35
    v_exp_f32 v36, v36
    v_exp_f32 v37, v37
    v_exp_f32 v38, v38
    v_exp_f32 v39, v39
    v_add_f32 v40, 1.0, v40
    v_add_f32 v41, 1.0, v41
    v_add_f32 v42, 1.0, v42
    v_add_f32 v43, 1.0, v43
    v_add_f32 v44, 1.0, v44
    v_add_f32 v45, 1.0, v45
    v_add_f32 v46, 1.0, v46
    v_add_f32 v47, 1.0, v47
    v_fma_f32 v40, v32, v40, v40
    v_fma_f32 v41, v33, v41, v41
    v_fma_f32 v42, v34, v42, v42
    v_fma_f32 v43, v35, v43, v43
    v_fma_f32 v44, v36, v44, v44
    v_fma_f32 v45, v37, v45, v45
    v_fma_f32 v46, v38, v46, v46
L_wp4:
    s_cbranch_execz L_wback
    v_fma_f32 v47, v39, v47, v47
    v_rcp_f32 v40, v40
    v_rcp_f32 v41, v41
    v_rcp_f32 v42, v42
    v_rcp_f32 v43, v43
    v_rcp_f32 v44, v44
    v_rcp_f32 v45, v45
    v_rcp_f32 v46, v46
    v_rcp_f32 v47, v47
    v_fma_f32 v32, v32, v40, -v40
    v_fma_f32 v33, v33, v41, -v41
    v_fma_f32 v34, v34, v42, -v42
    v_fma_f32 v35, v35, v43, -v43
    v_fma_f32 v36, v36, v44, -v44
    v_fma_f32 v37, v37, v45, -v45
    v_fma_f32 v38, v38, v46, -v46
    v_fma_f32 v39, v39, v47, -v47
    v_cvt_pk_bf16_f32 v72, v32, v33
    v_cvt_pk_bf16_f32 v73, v34, v35
    v_cvt_pk_bf16_f32 v74, v36, v37
    v_cvt_pk_bf16_f32 v75, v38, v39
    ds_write_b128 v251, v[72:75] offset:2048
    v_pk_mul_f32 v[48:49], v[48:49], s[40:41]
    v_pk_mul_f32 v[56:57], v[56:57], s[42:43]
    v_pk_mul_f32 v[50:51], v[50:51], s[40:41]
    v_pk_mul_f32 v[58:59], v[58:59], s[42:43]
    v_pk_mul_f32 v[52:53], v[52:53], s[40:41]
    v_pk_mul_f32 v[60:61], v[60:61], s[42:43]
    v_pk_mul_f32 v[54:55], v[54:55], s[40:41]
    v_pk_mul_f32 v[62:63], v[62:63], s[42:43]
    v_exp_f32 v56, v56
    v_exp_f32 v57, v57
    v_exp_f32 v58, v58
    v_exp_f32 v59, v59
    v_exp_f32 v60, v60
    v_exp_f32 v61, v61
    v_exp_f32 v62, v62
    v_exp_f32 v63, v63
    v_exp_f32 v48, v48
    v_exp_f32 v49, v49
    v_exp_f32 v50, v50
    v_exp_f32 v51, v51
    v_exp_f32 v52, v52
    v_exp_f32 v53, v53
    v_exp_f32 v54, v54
    v_exp_f32 v55, v55
    v_pk_add_f32 v[56:57], v[56:57], 1.0 op_sel_hi:[1,0]
    v_pk_add_f32 v[58:59], v[58:59], 1.0 op_sel_hi:[1,0]
    v_pk_add_f32 v[60:61], v[60:61], 1.0 op_sel_hi:[1,0]
    v_pk_add_f32 v[62:63], v[62:63], 1.0 op_sel_hi:[1,0]
    v_pk_fma_f32 v[56:57], v[48:49], v[56:57], v[56:57]
    v_pk_fma_f32 v[58:59], v[50:51], v[58:59], v[58:59]
    v_pk_fma_f32 v[60:61], v[52:53], v[60:61], v[60:61]
    v_pk_fma_f32 v[62:63], v[54:55], v[62:63], v[62:63]
    v_rcp_f32 v56, v56
    v_rcp_f32 v57, v57
    v_rcp_f32 v58, v58
    v_rcp_f32 v59, v59
    v_rcp_f32 v60, v60
    v_rcp_f32 v61, v61
    v_rcp_f32 v62, v62
    v_rcp_f32 v63, v63
    v_pk_fma_f32 v[48:49], v[48:49], v[56:57], v[56:57] neg_lo:[0,0,1] neg_hi:[0,0,1]
    v_pk_fma_f32 v[50:51], v[50:51], v[58:59], v[58:59] neg_lo:[0,0,1] neg_hi:[0,0,1]
    v_pk_fma_f32 v[52:53], v[52:53], v[60:61], v[60:61] neg_lo:[0,0,1] neg_hi:[0,0,1]
    v_pk_fma_f32 v[54:55], v[54:55], v[62:63], v[62:63] neg_lo:[0,0,1] neg_hi:[0,0,1]
    v_cvt_pk_bf16_f32 v76, v48, v49
    v_cvt_pk_bf16_f32 v77, v50, v51
    v_cvt_pk_bf16_f32 v78, v52, v53
    v_cvt_pk_bf16_f32 v79, v54, v55
    ds_write_b128 v252, v[76:79] offset:1024
    ds_read_b64 v[144:145], v224
    v_pk_mul_f32 v[0:1], v[0:1], s[40:41]
    v_pk_mul_f32 v[8:9], v[8:9], s[42:43]
    v_pk_mul_f32 v[2:3], v[2:3], s[40:41]
    v_pk_mul_f32 v[10:11], v[10:11], s[42:43]
    v_pk_mul_f32 v[4:5], v[4:5], s[40:41]
    v_pk_mul_f32 v[12:13], v[12:13], s[42:43]
    v_pk_mul_f32 v[6:7], v[6:7], s[40:41]
    v_pk_mul_f32 v[14:15], v[14:15], s[42:43]
    s_waitcnt lgkmcnt(1)
    s_barrier
    ds_read_b128 v[148:151], v253 offset:1024
    ds_read_b128 v[152:155], v253 offset:2048
    ds_read_b128 v[156:159], v253 offset:3072
    v_exp_f32 v8, v8
    s_waitcnt lgkmcnt(3)
    v_mfma_f32_16x16x16_bf16 v[16:19], v[160:161], v[144:145], 0
    v_exp_f32 v9, v9
    v_mfma_f32_16x16x16_bf16 v[20:23], v[162:163], v[144:145], 0
    v_exp_f32 v10, v10
    v_mfma_f32_16x16x16_bf16 v[24:27], v[164:165], v[144:145], 0
    v_exp_f32 v11, v11
    v_mfma_f32_16x16x16_bf16 v[28:31], v[166:167], v[144:145], 0
    v_exp_f32 v12, v12
    v_mfma_f32_16x16x16_bf16 v[32:35], v[168:169], v[144:145], 0
    v_exp_f32 v13, v13
    v_mfma_f32_16x16x16_bf16 v[36:39], v[170:171], v[144:145], 0
    v_exp_f32 v14, v14
    v_mfma_f32_16x16x16_bf16 v[40:43], v[172:173], v[144:145], 0
    v_exp_f32 v15, v15
    v_mfma_f32_16x16x16_bf16 v[44:47], v[174:175], v[144:145], 0
    v_exp_f32 v0, v0
    v_mfma_f32_16x16x16_bf16 v[48:51], v[176:177], v[144:145], 0
    v_exp_f32 v1, v1
    s_waitcnt lgkmcnt(2)
    v_mfma_f32_16x16x32_bf16 v[16:19], v[180:183], v[148:151], v[16:19]
    v_exp_f32 v2, v2
    v_mfma_f32_16x16x32_bf16 v[20:23], v[184:187], v[148:151], v[20:23]
    v_exp_f32 v3, v3
    v_mfma_f32_16x16x32_bf16 v[24:27], v[188:191], v[148:151], v[24:27]
    v_exp_f32 v4, v4
    v_mfma_f32_16x16x32_bf16 v[28:31], v[192:195], v[148:151], v[28:31]
    v_exp_f32 v5, v5
    v_exp_f32 v6, v6
    v_exp_f32 v7, v7
    v_pk_add_f32 v[8:9], v[8:9], 1.0 op_sel_hi:[1,0]
    v_pk_add_f32 v[10:11], v[10:11], 1.0 op_sel_hi:[1,0]
    v_pk_add_f32 v[12:13], v[12:13], 1.0 op_sel_hi:[1,0]
    v_pk_add_f32 v[14:15], v[14:15], 1.0 op_sel_hi:[1,0]
    v_pk_fma_f32 v[8:9], v[0:1], v[8:9], v[8:9]
    v_pk_fma_f32 v[10:11], v[2:3], v[10:11], v[10:11]
    v_pk_fma_f32 v[12:13], v[4:5], v[12:13], v[12:13]
    v_pk_fma_f32 v[14:15], v[6:7], v[14:15], v[14:15]
    v_rcp_f32 v8, v8
    v_mfma_f32_16x16x32_bf16 v[32:35], v[196:199], v[148:151], v[32:35]
    v_rcp_f32 v9, v9
    v_mfma_f32_16x16x32_bf16 v[36:39], v[200:203], v[148:151], v[36:39]
    v_rcp_f32 v10, v10
    v_mfma_f32_16x16x32_bf16 v[40:43], v[204:207], v[148:151], v[40:43]
    v_rcp_f32 v11, v11
    v_mfma_f32_16x16x32_bf16 v[44:47], v[208:211], v[148:151], v[44:47]
    v_rcp_f32 v12, v12
    v_mfma_f32_16x16x32_bf16 v[48:51], v[212:215], v[148:151], v[48:51]
    v_rcp_f32 v13, v13
    v_rcp_f32 v14, v14
    v_rcp_f32 v15, v15
    v_pk_fma_f32 v[0:1], v[0:1], v[8:9], v[8:9] neg_lo:[0,0,1] neg_hi:[0,0,1]
    v_pk_fma_f32 v[2:3], v[2:3], v[10:11], v[10:11] neg_lo:[0,0,1] neg_hi:[0,0,1]
    v_pk_fma_f32 v[4:5], v[4:5], v[12:13], v[12:13] neg_lo:[0,0,1] neg_hi:[0,0,1]
    v_pk_fma_f32 v[6:7], v[6:7], v[14:15], v[14:15] neg_lo:[0,0,1] neg_hi:[0,0,1]
    v_cvt_pk_bf16_f32 v64, v0, v1
    v_cvt_pk_bf16_f32 v65, v2, v3
    v_cvt_pk_bf16_f32 v66, v4, v5
    v_cvt_pk_bf16_f32 v67, v6, v7
    s_waitcnt lgkmcnt(1)
    v_mfma_f32_16x16x32_bf16 v[16:19], v[216:219], v[152:155], v[16:19]
    ds_read_b64_tr_b16 v[180:181], v239 offset:192
    ds_read_b64_tr_b16 v[182:183], v239 offset:4800
    s_waitcnt lgkmcnt(2)
    v_mfma_f32_16x16x32_bf16 v[16:19], v[220:223], v[156:159], v[16:19]
    ds_read_b64_tr_b16 v[184:185], v236 offset:192
    ds_read_b64_tr_b16 v[186:187], v236 offset:4800
    v_mfma_f32_16x16x32_bf16 v[16:19], v[80:83], v[64:67], v[16:19]
    ds_read_b64_tr_b16 v[188:189], v249 offset:192
    ds_read_b64_tr_b16 v[190:191], v249 offset:4800
    v_mfma_f32_16x16x32_bf16 v[20:23], v[84:87], v[152:155], v[20:23]
    ds_read_b64_tr_b16 v[192:193], v239 offset:224
    ds_read_b64_tr_b16 v[194:195], v239 offset:4832
    v_mfma_f32_16x16x32_bf16 v[20:23], v[88:91], v[156:159], v[20:23]
    ds_read_b64_tr_b16 v[196:197], v236 offset:224
    ds_read_b64_tr_b16 v[198:199], v236 offset:4832
    v_mfma_f32_16x16x32_bf16 v[20:23], v[92:95], v[64:67], v[20:23]
    v_cvt_pk_bf16_f32 v0, v16, v17
    v_cvt_pk_bf16_f32 v1, v18, v19
    v_mfma_f32_16x16x32_bf16 v[24:27], v[96:99], v[152:155], v[24:27]
    ds_write_b64 v242, v[0:1] offset:0
    v_mfma_f32_16x16x32_bf16 v[24:27], v[100:103], v[156:159], v[24:27]
    ds_read_b64_tr_b16 v[200:201], v249 offset:224
    ds_read_b64_tr_b16 v[202:203], v249 offset:4832
    v_mfma_f32_16x16x32_bf16 v[24:27], v[104:107], v[64:67], v[24:27]
    v_cvt_pk_bf16_f32 v2, v20, v21
    v_cvt_pk_bf16_f32 v3, v22, v23
    v_mfma_f32_16x16x32_bf16 v[28:31], v[108:111], v[152:155], v[28:31]
    ds_write_b64 v242, v[2:3] offset:32
    v_mfma_f32_16x16x32_bf16 v[28:31], v[112:115], v[156:159], v[28:31]
    ds_read_b64_tr_b16 v[204:205], v239 offset:256
    ds_read_b64_tr_b16 v[206:207], v239 offset:4864
    v_mfma_f32_16x16x32_bf16 v[28:31], v[116:119], v[64:67], v[28:31]
    v_cvt_pk_bf16_f32 v4, v24, v25
    v_cvt_pk_bf16_f32 v5, v26, v27
    v_mfma_f32_16x16x32_bf16 v[32:35], v[120:123], v[152:155], v[32:35]
    ds_write_b64 v242, v[4:5] offset:64
    v_mfma_f32_16x16x32_bf16 v[32:35], v[124:127], v[156:159], v[32:35]
    ds_read_b64_tr_b16 v[208:209], v236 offset:256
    ds_read_b64_tr_b16 v[210:211], v236 offset:4864
    v_mfma_f32_16x16x32_bf16 v[32:35], v[128:131], v[64:67], v[32:35]
    v_cvt_pk_bf16_f32 v6, v28, v29
    v_cvt_pk_bf16_f32 v7, v30, v31
    v_mfma_f32_16x16x32_bf16 v[36:39], v[132:135], v[152:155], v[36:39]
    ds_write_b64 v242, v[6:7] offset:96
    v_mfma_f32_16x16x32_bf16 v[36:39], v[136:139], v[156:159], v[36:39]
    ds_read_b64_tr_b16 v[212:213], v249 offset:256
    v_mfma_f32_16x16x32_bf16 v[36:39], v[140:143], v[64:67], v[36:39]
    ds_read_b64_tr_b16 v[214:215], v249 offset:4864
    s_waitcnt lgkmcnt(8)
    v_mfma_f32_16x16x32_bf16 v[40:43], v[180:183], v[152:155], v[40:43]
    v_cvt_pk_bf16_f32 v8, v32, v33
    v_cvt_pk_bf16_f32 v9, v34, v35
    v_mfma_f32_16x16x32_bf16 v[40:43], v[184:187], v[156:159], v[40:43]
    ds_write_b64 v242, v[8:9] offset:128
    v_mfma_f32_16x16x32_bf16 v[40:43], v[188:191], v[64:67], v[40:43]
    v_cvt_pk_bf16_f32 v10, v36, v37
    v_cvt_pk_bf16_f32 v11, v38, v39
    v_mfma_f32_16x16x32_bf16 v[44:47], v[192:195], v[152:155], v[44:47]
    ds_write_b64 v242, v[10:11] offset:160
    v_mfma_f32_16x16x32_bf16 v[44:47], v[196:199], v[156:159], v[44:47]
    v_mfma_f32_16x16x32_bf16 v[44:47], v[200:203], v[64:67], v[44:47]
    s_waitcnt lgkmcnt(8)
    v_mfma_f32_16x16x32_bf16 v[48:51], v[204:207], v[152:155], v[48:51]
    v_cvt_pk_bf16_f32 v12, v40, v41
    v_cvt_pk_bf16_f32 v13, v42, v43
    s_waitcnt lgkmcnt(5)
    v_mfma_f32_16x16x32_bf16 v[48:51], v[208:211], v[156:159], v[48:51]
    ds_write_b64 v242, v[12:13] offset:192
    s_waitcnt lgkmcnt(3)
    v_mfma_f32_16x16x32_bf16 v[48:51], v[212:215], v[64:67], v[48:51]
    v_cvt_pk_bf16_f32 v14, v44, v45
    v_cvt_pk_bf16_f32 v15, v46, v47
    ds_write_b64 v242, v[14:15] offset:224
    s_nop 4
    v_cvt_pk_bf16_f32 v52, v48, v49
    v_cvt_pk_bf16_f32 v53, v50, v51
    ds_write_b64 v242, v[52:53] offset:256
    ds_read_b128 v[16:19], v243 offset:0
    ds_read_b128 v[20:23], v243 offset:1024
    ds_read_b128 v[24:27], v243 offset:2048
    ds_read_b128 v[28:31], v243 offset:3072
    ds_read_b128 v[32:35], v243 offset:4096
    s_waitcnt lgkmcnt(4)
    buffer_store_dwordx4 v[16:19], v244, s[28:31], 0 offen sc1
    s_waitcnt lgkmcnt(3)
    buffer_store_dwordx4 v[20:23], v245, s[28:31], 0 offen sc1
    s_waitcnt lgkmcnt(2)
    buffer_store_dwordx4 v[24:27], v246, s[28:31], 0 offen sc1
    s_waitcnt lgkmcnt(1)
    buffer_store_dwordx4 v[28:31], v247, s[28:31], 0 offen sc1
    s_waitcnt lgkmcnt(0)
    s_mov_b32 exec_hi, 0
    buffer_store_dwordx4 v[32:35], v248, s[28:31], 0 offen sc1
    s_mov_b32 exec_hi, -1
L_end:
    s_endpgm
L_code_end:
L_clampU:
    v_med3_f32 v0, v0, -s44, s44
    v_med3_f32 v1, v1, -s44, s44
    v_med3_f32 v2, v2, -s44, s44
    v_med3_f32 v3, v3, -s44, s44
    v_med3_f32 v4, v4, -s44, s44
    v_med3_f32 v5, v5, -s44, s44
    v_med3_f32 v6, v6, -s44, s44
    v_med3_f32 v7, v7, -s44, s44
    v_med3_f32 v64, v64, -s44, s44
    v_med3_f32 v65, v65, -s44, s44
    v_med3_f32 v66, v66, -s44, s44
    v_med3_f32 v67, v67, -s44, s44
    v_med3_f32 v68, v68, -s44, s44
    v_med3_f32 v69, v69, -s44, s44
    v_med3_f32 v70, v70, -s44, s44
    v_med3_f32 v71, v71, -s44, s44
    v_med3_f32 v16, v16, -s44, s44
    v_med3_f32 v17, v17, -s44, s44
    v_med3_f32 v18, v18, -s44, s44
    v_med3_f32 v19, v19, -s44, s44
    v_med3_f32 v20, v20, -s44, s44
    v_med3_f32 v21, v21, -s44, s44
    v_med3_f32 v22, v22, -s44, s44
    v_med3_f32 v23, v23, -s44, s44
    v_med3_f32 v32, v32, -s44, s44
    v_med3_f32 v33, v33, -s44, s44
    v_med3_f32 v34, v34, -s44, s44
    v_med3_f32 v35, v35, -s44, s44
    v_med3_f32 v36, v36, -s44, s44
    v_med3_f32 v37, v37, -s44, s44
    v_med3_f32 v38, v38, -s44, s44
    v_med3_f32 v39, v39, -s44, s44
    v_med3_f32 v48, v48, -s44, s44
    v_med3_f32 v49, v49, -s44, s44
    v_med3_f32 v50, v50, -s44, s44
    v_med3_f32 v51, v51, -s44, s44
    v_med3_f32 v52, v52, -s44, s44
    v_med3_f32 v53, v53, -s44, s44
    v_med3_f32 v54, v54, -s44, s44
    v_med3_f32 v55, v55, -s44, s44
    s_branch L_clampedU
L_clampV:
    v_med3_f32 v0, v0, -s44, s44
    v_med3_f32 v1, v1, -s44, s44
    v_med3_f32 v2, v2, -s44, s44
    v_med3_f32 v3, v3, -s44, s44
    v_med3_f32 v4, v4, -s44, s44
    v_med3_f32 v5, v5, -s44, s44
    v_med3_f32 v6, v6, -s44, s44
    v_med3_f32 v7, v7, -s44, s44
    v_med3_f32 v16, v16, -s44, s44
    v_med3_f32 v17, v17, -s44, s44
    v_med3_f32 v18, v18, -s44, s44
    v_med3_f32 v19, v19, -s44, s44
    v_med3_f32 v20, v20, -s44, s44
    v_med3_f32 v21, v21, -s44, s44
    v_med3_f32 v22, v22, -s44, s44
    v_med3_f32 v23, v23, -s44, s44
    v_med3_f32 v32, v32, -s44, s44
    v_med3_f32 v33, v33, -s44, s44
    v_med3_f32 v34, v34, -s44, s44
    v_med3_f32 v35, v35, -s44, s44
    v_med3_f32 v36, v36, -s44, s44
    v_med3_f32 v37, v37, -s44, s44
    v_med3_f32 v38, v38, -s44, s44
    v_med3_f32 v39, v39, -s44, s44
    v_med3_f32 v48, v48, -s44, s44
    v_med3_f32 v49, v49, -s44, s44
    v_med3_f32 v50, v50, -s44, s44
    v_med3_f32 v51, v51, -s44, s44
    v_med3_f32 v52, v52, -s44, s44
    v_med3_f32 v53, v53, -s44, s44
    v_med3_f32 v54, v54, -s44, s44
    v_med3_f32 v55, v55, -s44, s44
    s_branch L_clampedV
.section .rodata,"a"
.p2align 6
.amdhsa_kernel standalone__autoregressive_conv_wavenet__speech_kernel
  .amdhsa_next_free_vgpr 256
  .amdhsa_next_free_sgpr 64
  .amdhsa_accum_offset 256
  .amdhsa_group_segment_fixed_size 0
  .amdhsa_kernarg_size 48
  .amdhsa_user_sgpr_count 2
  .amdhsa_user_sgpr_kernarg_segment_ptr 1
  .amdhsa_system_sgpr_workgroup_id_x 1
.end_amdhsa_kernel
```
